```python
import torch

def _softmax(x, axis=-1):
    return torch.softmax(x, dim=axis)
def _gelu(x):
    return torch.nn.functional.gelu(x, approximate="tanh")
def _silu(x):
    return torch.nn.functional.silu(x)
def _sigmoid(x):
    return torch.sigmoid(x)
def _layernorm(x, axis=-1, eps=1e-5):
    m = x.mean(dim=axis, keepdim=True)
    v = x.var(dim=axis, keepdim=True, unbiased=False)
    return (x - m) / torch.sqrt(v + eps)
def _scatter_add(tgt, idx, src, axis=0):
    return tgt.clone().index_add_(axis, idx, src)
def _segment_sum(src, seg, n):
    out = torch.zeros((n,) + src.shape[1:], dtype=src.dtype)
    return out.index_add_(0, seg, src)
def _pad(x, pw):
    flat = tuple(v for pair in reversed(pw) for v in pair)
    return torch.nn.functional.pad(x, flat)

kernel_name = 'standalone__dense_activation_gelu__prompt'

def setup_inputs():

    _w = (lambda a: (lambda t: t.to(torch.bfloat16) if t.is_floating_point() else t)(torch.as_tensor(a)))
    B, S, D, F = 1, 2048, 1024, 3584
    return {
        "x": _w((lambda *s: torch.randn(*s, dtype=torch.bfloat16) * 0.05)(B, S, D)),
        "w1": _w((lambda *s: torch.randn(*s, dtype=torch.bfloat16) * 3.2)(D, F) * (D ** -0.5)),
        "b1": _w((lambda *s: torch.randn(*s, dtype=torch.bfloat16) * 3.2)(F) * 0.01),
        "w2": _w((lambda *s: torch.randn(*s, dtype=torch.bfloat16) * 0.05)(F, D) * (F ** -0.5)),
        "b2": _w((lambda *s: torch.randn(*s, dtype=torch.bfloat16) * 0.1)(D) * 0.01),
    }

def reference(x, w1, b1, w2, b2):
    h = torch.einsum("bsd,df->bsf", x, w1) + b1
    h = _gelu(h)
    return torch.einsum("bsf,fd->bsd", h, w2) + b2
```

```asm
; @launch grid=(256,1,1) block=(512,1,1) lds=163840
.amdgcn_target "amdgcn-amd-amdhsa--gfx950"
.text
.globl standalone__dense_activation_gelu__prompt_kernel
.p2align 8
.type standalone__dense_activation_gelu__prompt_kernel,@function
standalone__dense_activation_gelu__prompt_kernel:
    s_cmp_ge_u32 s2, 256
    s_cbranch_scc1 L_END
    s_load_dwordx8 s[4:11], s[0:1], 0
    s_load_dwordx8 s[12:19], s[0:1], 32
    v_lshrrev_b32 v1, 6, v0
    v_and_b32 v2, 63, v0
    v_readfirstlane_b32 s3, v1
    s_and_b32 s22, s2, 7
    s_lshr_b32 s23, s2, 3
    s_and_b32 s20, s22, 1
    s_lshl_b32 s20, s20, 3
    s_and_b32 s21, s23, 7
    s_add_u32 s20, s20, s21
    s_lshr_b32 s21, s22, 1
    s_lshl_b32 s21, s21, 2
    s_lshr_b32 s40, s23, 3
    s_add_u32 s21, s21, s40
    s_cmp_lt_u32 s3, 4
    s_cbranch_scc1 L_COMP
    s_lshr_b32 s41, s22, 1
    s_lshl_b32 s41, s41, 2
    s_lshl_b32 s42, s22, 3
    s_add_u32 s41, s41, s42
    s_add_u32 s42, s20, s21
    s_and_b32 s42, s42, 1
    s_lshl_b32 s42, s42, 1
    s_add_u32 s41, s41, s42
    s_and_b32 s41, s41, 15
    s_and_b32 s40, s3, 1
    s_cmp_gt_u32 s3, 5
    s_cbranch_scc1 L_LOADA
    v_bfe_u32 v4, v2, 2, 2
    v_mul_u32_u24 v4, 7168, v4
    v_lshrrev_b32 v3, 4, v2
    v_lshl_add_u32 v4, v3, 6, v4
    v_and_b32 v5, 3, v2
    v_lshl_add_u32 v4, v5, 4, v4
    s_mul_i32 s44, s21, 448
    s_lshl_b32 s45, s40, 8
    s_add_u32 s44, s44, s45
    v_add_u32 v8, s44, v4
    v_xor_b32 v4, 32, v8
    v_add_u32 v9, 28672, v8
    v_add_u32 v10, 57344, v4
    v_add_u32 v11, 86016, v4
    v_add_u32 v12, 114688, v8
    v_add_u32 v13, 143360, v8
    v_add_u32 v14, 172032, v4
    v_add_u32 v15, 200704, v4
    v_add_u32 v16, 229376, v8
    v_add_u32 v17, 258048, v8
    v_add_u32 v18, 286720, v4
    v_add_u32 v19, 315392, v4
    v_add_u32 v20, 344064, v8
    v_add_u32 v21, 372736, v8
    v_add_u32 v22, 401408, v4
    v_add_u32 v23, 430080, v4
    s_mul_i32 s41, s41, 458752
    s_lshl_b32 s42, s40, 10
    s_add_u32 s42, s42, 16384
    s_lshl_b32 s45, s40, 4
    s_lshr_b32 s45, -1, s45
    s_mov_b32 exec_hi, s45
    s_waitcnt lgkmcnt(0)
    s_mov_b32 s24, s6
    s_and_b32 s25, s7, 0xffff
    s_mov_b32 s26, 7340032
    s_mov_b32 s27, 0x20000
    s_add_u32 m0, s42, 98304
    s_add_u32 s46, s41, 458752
    buffer_load_dwordx4 v8, s[24:27], s41 offen lds
    s_add_u32 m0, s42, 100352
    s_cmp_eq_u32 s46, 7340032
    buffer_load_dwordx4 v9, s[24:27], s41 offen lds
    s_cselect_b32 s46, 0, s46
    s_add_u32 m0, s42, 102400
    s_nop 0
    buffer_load_dwordx4 v10, s[24:27], s41 offen lds
    s_add_u32 m0, s42, 104448
    s_nop 0
    buffer_load_dwordx4 v11, s[24:27], s41 offen lds
    s_add_u32 m0, s42, 106496
    s_nop 0
    buffer_load_dwordx4 v12, s[24:27], s41 offen lds
    s_add_u32 m0, s42, 108544
    s_nop 0
    buffer_load_dwordx4 v13, s[24:27], s41 offen lds
    s_add_u32 m0, s42, 110592
    s_nop 0
    buffer_load_dwordx4 v14, s[24:27], s41 offen lds
    s_add_u32 m0, s42, 112640
    s_nop 0
    buffer_load_dwordx4 v15, s[24:27], s41 offen lds
    s_add_u32 m0, s42, 114688
    s_nop 0
    buffer_load_dwordx4 v16, s[24:27], s41 offen lds
    s_add_u32 m0, s42, 116736
    s_nop 0
    buffer_load_dwordx4 v17, s[24:27], s41 offen lds
    s_add_u32 m0, s42, 118784
    s_nop 0
    buffer_load_dwordx4 v18, s[24:27], s41 offen lds
    s_add_u32 m0, s42, 120832
    s_nop 0
    buffer_load_dwordx4 v19, s[24:27], s41 offen lds
    s_add_u32 m0, s42, 122880
    s_nop 0
    buffer_load_dwordx4 v20, s[24:27], s41 offen lds
    s_add_u32 m0, s42, 124928
    s_nop 0
    buffer_load_dwordx4 v21, s[24:27], s41 offen lds
    s_add_u32 m0, s42, 126976
    s_nop 0
    buffer_load_dwordx4 v22, s[24:27], s41 offen lds
    s_add_u32 m0, s42, 129024
    s_nop 0
    buffer_load_dwordx4 v23, s[24:27], s41 offen lds
    s_mov_b32 s41, s46
    s_mov_b32 s28, s10
    s_and_b32 s29, s11, 0xffff
    s_mov_b32 s30, 7340032
    s_mov_b32 s31, 0x20000
    s_add_u32 m0, s42, 0
    s_add_u32 s46, s41, 458752
    buffer_load_dwordx4 v8, s[24:27], s41 offen lds
    s_add_u32 m0, s42, 2048
    s_cmp_eq_u32 s46, 7340032
    buffer_load_dwordx4 v9, s[24:27], s41 offen lds
    s_cselect_b32 s46, 0, s46
    s_add_u32 m0, s42, 4096
    s_nop 0
    buffer_load_dwordx4 v10, s[24:27], s41 offen lds
    s_add_u32 m0, s42, 6144
    s_nop 0
    buffer_load_dwordx4 v11, s[24:27], s41 offen lds
    s_add_u32 m0, s42, 8192
    s_nop 0
    buffer_load_dwordx4 v12, s[24:27], s41 offen lds
    s_add_u32 m0, s42, 10240
    s_nop 0
    buffer_load_dwordx4 v13, s[24:27], s41 offen lds
    s_add_u32 m0, s42, 12288
    s_nop 0
    buffer_load_dwordx4 v14, s[24:27], s41 offen lds
    s_add_u32 m0, s42, 14336
    s_nop 0
    buffer_load_dwordx4 v15, s[24:27], s41 offen lds
    s_add_u32 m0, s42, 16384
    s_nop 0
    buffer_load_dwordx4 v16, s[24:27], s41 offen lds
    s_add_u32 m0, s42, 18432
    s_nop 0
    buffer_load_dwordx4 v17, s[24:27], s41 offen lds
    s_add_u32 m0, s42, 20480
    s_nop 0
    buffer_load_dwordx4 v18, s[24:27], s41 offen lds
    s_add_u32 m0, s42, 22528
    s_nop 0
    buffer_load_dwordx4 v19, s[24:27], s41 offen lds
    s_add_u32 m0, s42, 24576
    s_nop 0
    buffer_load_dwordx4 v20, s[24:27], s41 offen lds
    s_add_u32 m0, s42, 26624
    s_nop 0
    buffer_load_dwordx4 v21, s[24:27], s41 offen lds
    s_add_u32 m0, s42, 28672
    s_nop 0
    buffer_load_dwordx4 v22, s[24:27], s41 offen lds
    s_add_u32 m0, s42, 30720
    s_nop 0
    buffer_load_dwordx4 v23, s[24:27], s41 offen lds
    s_mov_b32 s41, s46
    s_waitcnt vmcnt(16)
    s_barrier
    s_add_u32 m0, s42, 49152
    s_add_u32 s46, s41, 458752
    buffer_load_dwordx4 v8, s[24:27], s41 offen lds
    s_add_u32 m0, s42, 51200
    s_cmp_eq_u32 s46, 7340032
    buffer_load_dwordx4 v9, s[24:27], s41 offen lds
    s_cselect_b32 s46, 0, s46
    s_add_u32 m0, s42, 53248
    s_nop 0
    buffer_load_dwordx4 v10, s[24:27], s41 offen lds
    s_add_u32 m0, s42, 55296
    s_nop 0
    buffer_load_dwordx4 v11, s[24:27], s41 offen lds
    s_add_u32 m0, s42, 57344
    s_nop 0
    buffer_load_dwordx4 v12, s[24:27], s41 offen lds
    s_add_u32 m0, s42, 59392
    s_nop 0
    buffer_load_dwordx4 v13, s[24:27], s41 offen lds
    s_add_u32 m0, s42, 61440
    s_nop 0
    buffer_load_dwordx4 v14, s[24:27], s41 offen lds
    s_add_u32 m0, s42, 63488
    s_nop 0
    buffer_load_dwordx4 v15, s[24:27], s41 offen lds
    s_add_u32 m0, s42, 65536
    s_nop 0
    buffer_load_dwordx4 v16, s[24:27], s41 offen lds
    s_add_u32 m0, s42, 67584
    s_nop 0
    buffer_load_dwordx4 v17, s[24:27], s41 offen lds
    s_add_u32 m0, s42, 69632
    s_nop 0
    buffer_load_dwordx4 v18, s[24:27], s41 offen lds
    s_add_u32 m0, s42, 71680
    s_nop 0
    buffer_load_dwordx4 v19, s[24:27], s41 offen lds
    s_add_u32 m0, s42, 73728
    s_nop 0
    buffer_load_dwordx4 v20, s[24:27], s41 offen lds
    s_add_u32 m0, s42, 75776
    s_nop 0
    buffer_load_dwordx4 v21, s[24:27], s41 offen lds
    s_add_u32 m0, s42, 77824
    s_nop 0
    buffer_load_dwordx4 v22, s[24:27], s41 offen lds
    s_add_u32 m0, s42, 79872
    s_nop 0
    buffer_load_dwordx4 v23, s[24:27], s41 offen lds
    s_mov_b32 s41, s46
    v_bfe_u32 v27, v2, 3, 2
    v_and_b32 v25, 7, v2
    v_lshlrev_b32 v25, 7, v25
    v_lshl_add_u32 v27, v27, 11, v25
    s_lshr_b32 s53, s22, 2
    s_mul_i32 s53, s53, 1792
    s_lshl_b32 s54, s23, 3
    s_add_u32 s53, s53, s54
    s_lshl_b32 s54, s40, 2
    s_add_u32 s53, s53, s54
    s_and_b32 s54, s22, 1
    s_mul_i32 s54, s54, 896
    s_add_u32 s53, s53, s54
    s_lshl_b32 s53, s53, 11
    s_bfe_u32 s54, s22, 0x10001
    s_lshl_b32 s54, s54, 10
    s_add_u32 s53, s53, s54
    s_add_u32 s54, s53, 0
    buffer_load_dword v26, v27, s[28:31], s54 offen
    s_waitcnt vmcnt(17)
    s_barrier
    s_add_u32 m0, s42, 98304
    s_add_u32 s46, s41, 458752
    buffer_load_dwordx4 v8, s[24:27], s41 offen lds
    s_add_u32 m0, s42, 100352
    s_cmp_eq_u32 s46, 7340032
    buffer_load_dwordx4 v9, s[24:27], s41 offen lds
    s_cselect_b32 s46, 0, s46
    s_add_u32 m0, s42, 102400
    s_nop 0
    buffer_load_dwordx4 v10, s[24:27], s41 offen lds
    s_add_u32 m0, s42, 104448
    s_nop 0
    buffer_load_dwordx4 v11, s[24:27], s41 offen lds
    s_add_u32 m0, s42, 106496
    s_nop 0
    buffer_load_dwordx4 v12, s[24:27], s41 offen lds
    s_add_u32 m0, s42, 108544
    s_nop 0
    buffer_load_dwordx4 v13, s[24:27], s41 offen lds
    s_add_u32 m0, s42, 110592
    s_nop 0
    buffer_load_dwordx4 v14, s[24:27], s41 offen lds
    s_add_u32 m0, s42, 112640
    s_nop 0
    buffer_load_dwordx4 v15, s[24:27], s41 offen lds
    s_add_u32 m0, s42, 114688
    s_nop 0
    buffer_load_dwordx4 v16, s[24:27], s41 offen lds
    s_add_u32 m0, s42, 116736
    s_nop 0
    buffer_load_dwordx4 v17, s[24:27], s41 offen lds
    s_add_u32 m0, s42, 118784
    s_nop 0
    buffer_load_dwordx4 v18, s[24:27], s41 offen lds
    s_add_u32 m0, s42, 120832
    s_nop 0
    buffer_load_dwordx4 v19, s[24:27], s41 offen lds
    s_add_u32 m0, s42, 122880
    s_nop 0
    buffer_load_dwordx4 v20, s[24:27], s41 offen lds
    s_add_u32 m0, s42, 124928
    s_nop 0
    buffer_load_dwordx4 v21, s[24:27], s41 offen lds
    s_add_u32 m0, s42, 126976
    s_nop 0
    buffer_load_dwordx4 v22, s[24:27], s41 offen lds
    s_add_u32 m0, s42, 129024
    s_nop 0
    buffer_load_dwordx4 v23, s[24:27], s41 offen lds
    s_mov_b32 s41, s46
    s_waitcnt vmcnt(17)
    s_barrier
    s_add_u32 m0, s42, 0
    s_add_u32 s46, s41, 458752
    buffer_load_dwordx4 v8, s[24:27], s41 offen lds
    s_add_u32 m0, s42, 2048
    s_cmp_eq_u32 s46, 7340032
    buffer_load_dwordx4 v9, s[24:27], s41 offen lds
    s_cselect_b32 s46, 0, s46
    s_add_u32 m0, s42, 4096
    s_nop 0
    buffer_load_dwordx4 v10, s[24:27], s41 offen lds
    s_add_u32 m0, s42, 6144
    s_nop 0
    buffer_load_dwordx4 v11, s[24:27], s41 offen lds
    s_add_u32 m0, s42, 8192
    s_nop 0
    buffer_load_dwordx4 v12, s[24:27], s41 offen lds
    s_add_u32 m0, s42, 10240
    s_nop 0
    buffer_load_dwordx4 v13, s[24:27], s41 offen lds
    s_add_u32 m0, s42, 12288
    s_nop 0
    buffer_load_dwordx4 v14, s[24:27], s41 offen lds
    s_add_u32 m0, s42, 14336
    s_nop 0
    buffer_load_dwordx4 v15, s[24:27], s41 offen lds
    s_add_u32 m0, s42, 16384
    s_nop 0
    buffer_load_dwordx4 v16, s[24:27], s41 offen lds
    s_add_u32 m0, s42, 18432
    s_nop 0
    buffer_load_dwordx4 v17, s[24:27], s41 offen lds
    s_add_u32 m0, s42, 20480
    s_nop 0
    buffer_load_dwordx4 v18, s[24:27], s41 offen lds
    s_add_u32 m0, s42, 22528
    s_nop 0
    buffer_load_dwordx4 v19, s[24:27], s41 offen lds
    s_add_u32 m0, s42, 24576
    s_nop 0
    buffer_load_dwordx4 v20, s[24:27], s41 offen lds
    s_add_u32 m0, s42, 26624
    s_nop 0
    buffer_load_dwordx4 v21, s[24:27], s41 offen lds
    s_add_u32 m0, s42, 28672
    s_nop 0
    buffer_load_dwordx4 v22, s[24:27], s41 offen lds
    s_add_u32 m0, s42, 30720
    s_nop 0
    buffer_load_dwordx4 v23, s[24:27], s41 offen lds
    s_mov_b32 s41, s46
    s_waitcnt vmcnt(16)
    s_barrier
    s_add_u32 m0, s42, 49152
    s_add_u32 s46, s41, 458752
    buffer_load_dwordx4 v8, s[24:27], s41 offen lds
    s_add_u32 m0, s42, 51200
    s_cmp_eq_u32 s46, 7340032
    buffer_load_dwordx4 v9, s[24:27], s41 offen lds
    s_cselect_b32 s46, 0, s46
    s_add_u32 m0, s42, 53248
    s_nop 0
    buffer_load_dwordx4 v10, s[24:27], s41 offen lds
    s_add_u32 m0, s42, 55296
    s_nop 0
    buffer_load_dwordx4 v11, s[24:27], s41 offen lds
    s_add_u32 m0, s42, 57344
    s_nop 0
    buffer_load_dwordx4 v12, s[24:27], s41 offen lds
    s_add_u32 m0, s42, 59392
    s_nop 0
    buffer_load_dwordx4 v13, s[24:27], s41 offen lds
    s_add_u32 m0, s42, 61440
    s_nop 0
    buffer_load_dwordx4 v14, s[24:27], s41 offen lds
    s_add_u32 m0, s42, 63488
    s_nop 0
    buffer_load_dwordx4 v15, s[24:27], s41 offen lds
    s_add_u32 m0, s42, 65536
    s_nop 0
    buffer_load_dwordx4 v16, s[24:27], s41 offen lds
    s_add_u32 m0, s42, 67584
    s_nop 0
    buffer_load_dwordx4 v17, s[24:27], s41 offen lds
    s_add_u32 m0, s42, 69632
    s_nop 0
    buffer_load_dwordx4 v18, s[24:27], s41 offen lds
    s_add_u32 m0, s42, 71680
    s_nop 0
    buffer_load_dwordx4 v19, s[24:27], s41 offen lds
    s_add_u32 m0, s42, 73728
    s_nop 0
    buffer_load_dwordx4 v20, s[24:27], s41 offen lds
    s_add_u32 m0, s42, 75776
    s_nop 0
    buffer_load_dwordx4 v21, s[24:27], s41 offen lds
    s_add_u32 m0, s42, 77824
    s_nop 0
    buffer_load_dwordx4 v22, s[24:27], s41 offen lds
    s_add_u32 m0, s42, 79872
    s_nop 0
    buffer_load_dwordx4 v23, s[24:27], s41 offen lds
    s_mov_b32 s41, s46
    s_add_u32 s54, s53, 524288
    buffer_load_dword v26, v27, s[28:31], s54 offen
    s_waitcnt vmcnt(17)
    s_barrier
    s_add_u32 m0, s42, 98304
    s_add_u32 s46, s41, 458752
    buffer_load_dwordx4 v8, s[24:27], s41 offen lds
    s_add_u32 m0, s42, 100352
    s_cmp_eq_u32 s46, 7340032
    buffer_load_dwordx4 v9, s[24:27], s41 offen lds
    s_cselect_b32 s46, 0, s46
    s_add_u32 m0, s42, 102400
    s_nop 0
    buffer_load_dwordx4 v10, s[24:27], s41 offen lds
    s_add_u32 m0, s42, 104448
    s_nop 0
    buffer_load_dwordx4 v11, s[24:27], s41 offen lds
    s_add_u32 m0, s42, 106496
    s_nop 0
    buffer_load_dwordx4 v12, s[24:27], s41 offen lds
    s_add_u32 m0, s42, 108544
    s_nop 0
    buffer_load_dwordx4 v13, s[24:27], s41 offen lds
    s_add_u32 m0, s42, 110592
    s_nop 0
    buffer_load_dwordx4 v14, s[24:27], s41 offen lds
    s_add_u32 m0, s42, 112640
    s_nop 0
    buffer_load_dwordx4 v15, s[24:27], s41 offen lds
    s_add_u32 m0, s42, 114688
    s_nop 0
    buffer_load_dwordx4 v16, s[24:27], s41 offen lds
    s_add_u32 m0, s42, 116736
    s_nop 0
    buffer_load_dwordx4 v17, s[24:27], s41 offen lds
    s_add_u32 m0, s42, 118784
    s_nop 0
    buffer_load_dwordx4 v18, s[24:27], s41 offen lds
    s_add_u32 m0, s42, 120832
    s_nop 0
    buffer_load_dwordx4 v19, s[24:27], s41 offen lds
    s_add_u32 m0, s42, 122880
    s_nop 0
    buffer_load_dwordx4 v20, s[24:27], s41 offen lds
    s_add_u32 m0, s42, 124928
    s_nop 0
    buffer_load_dwordx4 v21, s[24:27], s41 offen lds
    s_add_u32 m0, s42, 126976
    s_nop 0
    buffer_load_dwordx4 v22, s[24:27], s41 offen lds
    s_add_u32 m0, s42, 129024
    s_nop 0
    buffer_load_dwordx4 v23, s[24:27], s41 offen lds
    s_mov_b32 s41, s46
    s_waitcnt vmcnt(17)
    s_barrier
    s_add_u32 m0, s42, 0
    s_add_u32 s46, s41, 458752
    buffer_load_dwordx4 v8, s[24:27], s41 offen lds
    s_add_u32 m0, s42, 2048
    s_cmp_eq_u32 s46, 7340032
    buffer_load_dwordx4 v9, s[24:27], s41 offen lds
    s_cselect_b32 s46, 0, s46
    s_add_u32 m0, s42, 4096
    s_nop 0
    buffer_load_dwordx4 v10, s[24:27], s41 offen lds
    s_add_u32 m0, s42, 6144
    s_nop 0
    buffer_load_dwordx4 v11, s[24:27], s41 offen lds
    s_add_u32 m0, s42, 8192
    s_nop 0
    buffer_load_dwordx4 v12, s[24:27], s41 offen lds
    s_add_u32 m0, s42, 10240
    s_nop 0
    buffer_load_dwordx4 v13, s[24:27], s41 offen lds
    s_add_u32 m0, s42, 12288
    s_nop 0
    buffer_load_dwordx4 v14, s[24:27], s41 offen lds
    s_add_u32 m0, s42, 14336
    s_nop 0
    buffer_load_dwordx4 v15, s[24:27], s41 offen lds
    s_add_u32 m0, s42, 16384
    s_nop 0
    buffer_load_dwordx4 v16, s[24:27], s41 offen lds
    s_add_u32 m0, s42, 18432
    s_nop 0
    buffer_load_dwordx4 v17, s[24:27], s41 offen lds
    s_add_u32 m0, s42, 20480
    s_nop 0
    buffer_load_dwordx4 v18, s[24:27], s41 offen lds
    s_add_u32 m0, s42, 22528
    s_nop 0
    buffer_load_dwordx4 v19, s[24:27], s41 offen lds
    s_add_u32 m0, s42, 24576
    s_nop 0
    buffer_load_dwordx4 v20, s[24:27], s41 offen lds
    s_add_u32 m0, s42, 26624
    s_nop 0
    buffer_load_dwordx4 v21, s[24:27], s41 offen lds
    s_add_u32 m0, s42, 28672
    s_nop 0
    buffer_load_dwordx4 v22, s[24:27], s41 offen lds
    s_add_u32 m0, s42, 30720
    s_nop 0
    buffer_load_dwordx4 v23, s[24:27], s41 offen lds
    s_mov_b32 s41, s46
    s_waitcnt vmcnt(16)
    s_barrier
    s_add_u32 m0, s42, 49152
    s_add_u32 s46, s41, 458752
    buffer_load_dwordx4 v8, s[24:27], s41 offen lds
    s_add_u32 m0, s42, 51200
    s_cmp_eq_u32 s46, 7340032
    buffer_load_dwordx4 v9, s[24:27], s41 offen lds
    s_cselect_b32 s46, 0, s46
    s_add_u32 m0, s42, 53248
    s_nop 0
    buffer_load_dwordx4 v10, s[24:27], s41 offen lds
    s_add_u32 m0, s42, 55296
    s_nop 0
    buffer_load_dwordx4 v11, s[24:27], s41 offen lds
    s_add_u32 m0, s42, 57344
    s_nop 0
    buffer_load_dwordx4 v12, s[24:27], s41 offen lds
    s_add_u32 m0, s42, 59392
    s_nop 0
    buffer_load_dwordx4 v13, s[24:27], s41 offen lds
    s_add_u32 m0, s42, 61440
    s_nop 0
    buffer_load_dwordx4 v14, s[24:27], s41 offen lds
    s_add_u32 m0, s42, 63488
    s_nop 0
    buffer_load_dwordx4 v15, s[24:27], s41 offen lds
    s_add_u32 m0, s42, 65536
    s_nop 0
    buffer_load_dwordx4 v16, s[24:27], s41 offen lds
    s_add_u32 m0, s42, 67584
    s_nop 0
    buffer_load_dwordx4 v17, s[24:27], s41 offen lds
    s_add_u32 m0, s42, 69632
    s_nop 0
    buffer_load_dwordx4 v18, s[24:27], s41 offen lds
    s_add_u32 m0, s42, 71680
    s_nop 0
    buffer_load_dwordx4 v19, s[24:27], s41 offen lds
    s_add_u32 m0, s42, 73728
    s_nop 0
    buffer_load_dwordx4 v20, s[24:27], s41 offen lds
    s_add_u32 m0, s42, 75776
    s_nop 0
    buffer_load_dwordx4 v21, s[24:27], s41 offen lds
    s_add_u32 m0, s42, 77824
    s_nop 0
    buffer_load_dwordx4 v22, s[24:27], s41 offen lds
    s_add_u32 m0, s42, 79872
    s_nop 0
    buffer_load_dwordx4 v23, s[24:27], s41 offen lds
    s_mov_b32 s41, s46
    s_add_u32 s54, s53, 1048576
    buffer_load_dword v26, v27, s[28:31], s54 offen
    s_waitcnt vmcnt(17)
    s_barrier
    s_add_u32 m0, s42, 98304
    s_add_u32 s46, s41, 458752
    buffer_load_dwordx4 v8, s[24:27], s41 offen lds
    s_add_u32 m0, s42, 100352
    s_cmp_eq_u32 s46, 7340032
    buffer_load_dwordx4 v9, s[24:27], s41 offen lds
    s_cselect_b32 s46, 0, s46
    s_add_u32 m0, s42, 102400
    s_nop 0
    buffer_load_dwordx4 v10, s[24:27], s41 offen lds
    s_add_u32 m0, s42, 104448
    s_nop 0
    buffer_load_dwordx4 v11, s[24:27], s41 offen lds
    s_add_u32 m0, s42, 106496
    s_nop 0
    buffer_load_dwordx4 v12, s[24:27], s41 offen lds
    s_add_u32 m0, s42, 108544
    s_nop 0
    buffer_load_dwordx4 v13, s[24:27], s41 offen lds
    s_add_u32 m0, s42, 110592
    s_nop 0
    buffer_load_dwordx4 v14, s[24:27], s41 offen lds
    s_add_u32 m0, s42, 112640
    s_nop 0
    buffer_load_dwordx4 v15, s[24:27], s41 offen lds
    s_add_u32 m0, s42, 114688
    s_nop 0
    buffer_load_dwordx4 v16, s[24:27], s41 offen lds
    s_add_u32 m0, s42, 116736
    s_nop 0
    buffer_load_dwordx4 v17, s[24:27], s41 offen lds
    s_add_u32 m0, s42, 118784
    s_nop 0
    buffer_load_dwordx4 v18, s[24:27], s41 offen lds
    s_add_u32 m0, s42, 120832
    s_nop 0
    buffer_load_dwordx4 v19, s[24:27], s41 offen lds
    s_add_u32 m0, s42, 122880
    s_nop 0
    buffer_load_dwordx4 v20, s[24:27], s41 offen lds
    s_add_u32 m0, s42, 124928
    s_nop 0
    buffer_load_dwordx4 v21, s[24:27], s41 offen lds
    s_add_u32 m0, s42, 126976
    s_nop 0
    buffer_load_dwordx4 v22, s[24:27], s41 offen lds
    s_add_u32 m0, s42, 129024
    s_nop 0
    buffer_load_dwordx4 v23, s[24:27], s41 offen lds
    s_mov_b32 s41, s46
    s_waitcnt vmcnt(17)
    s_barrier
    s_add_u32 m0, s42, 0
    s_add_u32 s46, s41, 458752
    buffer_load_dwordx4 v8, s[24:27], s41 offen lds
    s_add_u32 m0, s42, 2048
    s_cmp_eq_u32 s46, 7340032
    buffer_load_dwordx4 v9, s[24:27], s41 offen lds
    s_cselect_b32 s46, 0, s46
    s_add_u32 m0, s42, 4096
    s_nop 0
    buffer_load_dwordx4 v10, s[24:27], s41 offen lds
    s_add_u32 m0, s42, 6144
    s_nop 0
    buffer_load_dwordx4 v11, s[24:27], s41 offen lds
    s_add_u32 m0, s42, 8192
    s_nop 0
    buffer_load_dwordx4 v12, s[24:27], s41 offen lds
    s_add_u32 m0, s42, 10240
    s_nop 0
    buffer_load_dwordx4 v13, s[24:27], s41 offen lds
    s_add_u32 m0, s42, 12288
    s_nop 0
    buffer_load_dwordx4 v14, s[24:27], s41 offen lds
    s_add_u32 m0, s42, 14336
    s_nop 0
    buffer_load_dwordx4 v15, s[24:27], s41 offen lds
    s_add_u32 m0, s42, 16384
    s_nop 0
    buffer_load_dwordx4 v16, s[24:27], s41 offen lds
    s_add_u32 m0, s42, 18432
    s_nop 0
    buffer_load_dwordx4 v17, s[24:27], s41 offen lds
    s_add_u32 m0, s42, 20480
    s_nop 0
    buffer_load_dwordx4 v18, s[24:27], s41 offen lds
    s_add_u32 m0, s42, 22528
    s_nop 0
    buffer_load_dwordx4 v19, s[24:27], s41 offen lds
    s_add_u32 m0, s42, 24576
    s_nop 0
    buffer_load_dwordx4 v20, s[24:27], s41 offen lds
    s_add_u32 m0, s42, 26624
    s_nop 0
    buffer_load_dwordx4 v21, s[24:27], s41 offen lds
    s_add_u32 m0, s42, 28672
    s_nop 0
    buffer_load_dwordx4 v22, s[24:27], s41 offen lds
    s_add_u32 m0, s42, 30720
    s_nop 0
    buffer_load_dwordx4 v23, s[24:27], s41 offen lds
    s_mov_b32 s41, s46
    s_waitcnt vmcnt(16)
    s_barrier
    s_add_u32 m0, s42, 49152
    s_add_u32 s46, s41, 458752
    buffer_load_dwordx4 v8, s[24:27], s41 offen lds
    s_add_u32 m0, s42, 51200
    s_cmp_eq_u32 s46, 7340032
    buffer_load_dwordx4 v9, s[24:27], s41 offen lds
    s_cselect_b32 s46, 0, s46
    s_add_u32 m0, s42, 53248
    s_nop 0
    buffer_load_dwordx4 v10, s[24:27], s41 offen lds
    s_add_u32 m0, s42, 55296
    s_nop 0
    buffer_load_dwordx4 v11, s[24:27], s41 offen lds
    s_add_u32 m0, s42, 57344
    s_nop 0
    buffer_load_dwordx4 v12, s[24:27], s41 offen lds
    s_add_u32 m0, s42, 59392
    s_nop 0
    buffer_load_dwordx4 v13, s[24:27], s41 offen lds
    s_add_u32 m0, s42, 61440
    s_nop 0
    buffer_load_dwordx4 v14, s[24:27], s41 offen lds
    s_add_u32 m0, s42, 63488
    s_nop 0
    buffer_load_dwordx4 v15, s[24:27], s41 offen lds
    s_add_u32 m0, s42, 65536
    s_nop 0
    buffer_load_dwordx4 v16, s[24:27], s41 offen lds
    s_add_u32 m0, s42, 67584
    s_nop 0
    buffer_load_dwordx4 v17, s[24:27], s41 offen lds
    s_add_u32 m0, s42, 69632
    s_nop 0
    buffer_load_dwordx4 v18, s[24:27], s41 offen lds
    s_add_u32 m0, s42, 71680
    s_nop 0
    buffer_load_dwordx4 v19, s[24:27], s41 offen lds
    s_add_u32 m0, s42, 73728
    s_nop 0
    buffer_load_dwordx4 v20, s[24:27], s41 offen lds
    s_add_u32 m0, s42, 75776
    s_nop 0
    buffer_load_dwordx4 v21, s[24:27], s41 offen lds
    s_add_u32 m0, s42, 77824
    s_nop 0
    buffer_load_dwordx4 v22, s[24:27], s41 offen lds
    s_add_u32 m0, s42, 79872
    s_nop 0
    buffer_load_dwordx4 v23, s[24:27], s41 offen lds
    s_mov_b32 s41, s46
    s_add_u32 s54, s53, 1572864
    buffer_load_dword v26, v27, s[28:31], s54 offen
    s_waitcnt vmcnt(17)
    s_barrier
    s_add_u32 m0, s42, 98304
    s_add_u32 s46, s41, 458752
    buffer_load_dwordx4 v8, s[24:27], s41 offen lds
    s_add_u32 m0, s42, 100352
    s_cmp_eq_u32 s46, 7340032
    buffer_load_dwordx4 v9, s[24:27], s41 offen lds
    s_cselect_b32 s46, 0, s46
    s_add_u32 m0, s42, 102400
    s_nop 0
    buffer_load_dwordx4 v10, s[24:27], s41 offen lds
    s_add_u32 m0, s42, 104448
    s_nop 0
    buffer_load_dwordx4 v11, s[24:27], s41 offen lds
    s_add_u32 m0, s42, 106496
    s_nop 0
    buffer_load_dwordx4 v12, s[24:27], s41 offen lds
    s_add_u32 m0, s42, 108544
    s_nop 0
    buffer_load_dwordx4 v13, s[24:27], s41 offen lds
    s_add_u32 m0, s42, 110592
    s_nop 0
    buffer_load_dwordx4 v14, s[24:27], s41 offen lds
    s_add_u32 m0, s42, 112640
    s_nop 0
    buffer_load_dwordx4 v15, s[24:27], s41 offen lds
    s_add_u32 m0, s42, 114688
    s_nop 0
    buffer_load_dwordx4 v16, s[24:27], s41 offen lds
    s_add_u32 m0, s42, 116736
    s_nop 0
    buffer_load_dwordx4 v17, s[24:27], s41 offen lds
    s_add_u32 m0, s42, 118784
    s_nop 0
    buffer_load_dwordx4 v18, s[24:27], s41 offen lds
    s_add_u32 m0, s42, 120832
    s_nop 0
    buffer_load_dwordx4 v19, s[24:27], s41 offen lds
    s_add_u32 m0, s42, 122880
    s_nop 0
    buffer_load_dwordx4 v20, s[24:27], s41 offen lds
    s_add_u32 m0, s42, 124928
    s_nop 0
    buffer_load_dwordx4 v21, s[24:27], s41 offen lds
    s_add_u32 m0, s42, 126976
    s_nop 0
    buffer_load_dwordx4 v22, s[24:27], s41 offen lds
    s_add_u32 m0, s42, 129024
    s_nop 0
    buffer_load_dwordx4 v23, s[24:27], s41 offen lds
    s_mov_b32 s41, s46
    s_waitcnt vmcnt(17)
    s_barrier
    s_add_u32 m0, s42, 0
    s_add_u32 s46, s41, 458752
    buffer_load_dwordx4 v8, s[24:27], s41 offen lds
    s_add_u32 m0, s42, 2048
    s_cmp_eq_u32 s46, 7340032
    buffer_load_dwordx4 v9, s[24:27], s41 offen lds
    s_cselect_b32 s46, 0, s46
    s_add_u32 m0, s42, 4096
    s_nop 0
    buffer_load_dwordx4 v10, s[24:27], s41 offen lds
    s_add_u32 m0, s42, 6144
    s_nop 0
    buffer_load_dwordx4 v11, s[24:27], s41 offen lds
    s_add_u32 m0, s42, 8192
    s_nop 0
    buffer_load_dwordx4 v12, s[24:27], s41 offen lds
    s_add_u32 m0, s42, 10240
    s_nop 0
    buffer_load_dwordx4 v13, s[24:27], s41 offen lds
    s_add_u32 m0, s42, 12288
    s_nop 0
    buffer_load_dwordx4 v14, s[24:27], s41 offen lds
    s_add_u32 m0, s42, 14336
    s_nop 0
    buffer_load_dwordx4 v15, s[24:27], s41 offen lds
    s_add_u32 m0, s42, 16384
    s_nop 0
    buffer_load_dwordx4 v16, s[24:27], s41 offen lds
    s_add_u32 m0, s42, 18432
    s_nop 0
    buffer_load_dwordx4 v17, s[24:27], s41 offen lds
    s_add_u32 m0, s42, 20480
    s_nop 0
    buffer_load_dwordx4 v18, s[24:27], s41 offen lds
    s_add_u32 m0, s42, 22528
    s_nop 0
    buffer_load_dwordx4 v19, s[24:27], s41 offen lds
    s_add_u32 m0, s42, 24576
    s_nop 0
    buffer_load_dwordx4 v20, s[24:27], s41 offen lds
    s_add_u32 m0, s42, 26624
    s_nop 0
    buffer_load_dwordx4 v21, s[24:27], s41 offen lds
    s_add_u32 m0, s42, 28672
    s_nop 0
    buffer_load_dwordx4 v22, s[24:27], s41 offen lds
    s_add_u32 m0, s42, 30720
    s_nop 0
    buffer_load_dwordx4 v23, s[24:27], s41 offen lds
    s_mov_b32 s41, s46
    s_waitcnt vmcnt(16)
    s_barrier
    s_add_u32 m0, s42, 49152
    s_add_u32 s46, s41, 458752
    buffer_load_dwordx4 v8, s[24:27], s41 offen lds
    s_add_u32 m0, s42, 51200
    s_cmp_eq_u32 s46, 7340032
    buffer_load_dwordx4 v9, s[24:27], s41 offen lds
    s_cselect_b32 s46, 0, s46
    s_add_u32 m0, s42, 53248
    s_nop 0
    buffer_load_dwordx4 v10, s[24:27], s41 offen lds
    s_add_u32 m0, s42, 55296
    s_nop 0
    buffer_load_dwordx4 v11, s[24:27], s41 offen lds
    s_add_u32 m0, s42, 57344
    s_nop 0
    buffer_load_dwordx4 v12, s[24:27], s41 offen lds
    s_add_u32 m0, s42, 59392
    s_nop 0
    buffer_load_dwordx4 v13, s[24:27], s41 offen lds
    s_add_u32 m0, s42, 61440
    s_nop 0
    buffer_load_dwordx4 v14, s[24:27], s41 offen lds
    s_add_u32 m0, s42, 63488
    s_nop 0
    buffer_load_dwordx4 v15, s[24:27], s41 offen lds
    s_add_u32 m0, s42, 65536
    s_nop 0
    buffer_load_dwordx4 v16, s[24:27], s41 offen lds
    s_add_u32 m0, s42, 67584
    s_nop 0
    buffer_load_dwordx4 v17, s[24:27], s41 offen lds
    s_add_u32 m0, s42, 69632
    s_nop 0
    buffer_load_dwordx4 v18, s[24:27], s41 offen lds
    s_add_u32 m0, s42, 71680
    s_nop 0
    buffer_load_dwordx4 v19, s[24:27], s41 offen lds
    s_add_u32 m0, s42, 73728
    s_nop 0
    buffer_load_dwordx4 v20, s[24:27], s41 offen lds
    s_add_u32 m0, s42, 75776
    s_nop 0
    buffer_load_dwordx4 v21, s[24:27], s41 offen lds
    s_add_u32 m0, s42, 77824
    s_nop 0
    buffer_load_dwordx4 v22, s[24:27], s41 offen lds
    s_add_u32 m0, s42, 79872
    s_nop 0
    buffer_load_dwordx4 v23, s[24:27], s41 offen lds
    s_mov_b32 s41, s46
    s_waitcnt vmcnt(16)
    s_barrier
    s_add_u32 m0, s42, 98304
    s_add_u32 s46, s41, 458752
    buffer_load_dwordx4 v8, s[24:27], s41 offen lds
    s_add_u32 m0, s42, 100352
    s_cmp_eq_u32 s46, 7340032
    buffer_load_dwordx4 v9, s[24:27], s41 offen lds
    s_cselect_b32 s46, 0, s46
    s_add_u32 m0, s42, 102400
    s_nop 0
    buffer_load_dwordx4 v10, s[24:27], s41 offen lds
    s_add_u32 m0, s42, 104448
    s_nop 0
    buffer_load_dwordx4 v11, s[24:27], s41 offen lds
    s_add_u32 m0, s42, 106496
    s_nop 0
    buffer_load_dwordx4 v12, s[24:27], s41 offen lds
    s_add_u32 m0, s42, 108544
    s_nop 0
    buffer_load_dwordx4 v13, s[24:27], s41 offen lds
    s_add_u32 m0, s42, 110592
    s_nop 0
    buffer_load_dwordx4 v14, s[24:27], s41 offen lds
    s_add_u32 m0, s42, 112640
    s_nop 0
    buffer_load_dwordx4 v15, s[24:27], s41 offen lds
    s_add_u32 m0, s42, 114688
    s_nop 0
    buffer_load_dwordx4 v16, s[24:27], s41 offen lds
    s_add_u32 m0, s42, 116736
    s_nop 0
    buffer_load_dwordx4 v17, s[24:27], s41 offen lds
    s_add_u32 m0, s42, 118784
    s_nop 0
    buffer_load_dwordx4 v18, s[24:27], s41 offen lds
    s_add_u32 m0, s42, 120832
    s_nop 0
    buffer_load_dwordx4 v19, s[24:27], s41 offen lds
    s_add_u32 m0, s42, 122880
    s_nop 0
    buffer_load_dwordx4 v20, s[24:27], s41 offen lds
    s_add_u32 m0, s42, 124928
    s_nop 0
    buffer_load_dwordx4 v21, s[24:27], s41 offen lds
    s_add_u32 m0, s42, 126976
    s_nop 0
    buffer_load_dwordx4 v22, s[24:27], s41 offen lds
    s_add_u32 m0, s42, 129024
    s_nop 0
    buffer_load_dwordx4 v23, s[24:27], s41 offen lds
    s_mov_b32 s41, s46
    s_mov_b64 exec, -1
    v_lshrrev_b32 v3, 4, v2
    v_bfe_u32 v4, v2, 1, 3
    v_lshlrev_b32 v5, 1, v3
    v_xor_b32 v4, v4, v5
    v_lshlrev_b32 v4, 5, v4
    v_and_b32 v5, 1, v2
    v_lshl_add_u32 v4, v5, 4, v4
    v_lshl_add_u32 v4, v3, 11, v4
    s_lshr_b32 s44, s21, 3
    s_mul_i32 s44, s44, 3670016
    s_and_b32 s45, s21, 7
    s_lshl_b32 s46, s45, 8
    s_add_u32 s44, s44, s46
    v_add_u32 v30, s44, v4
    v_add_u32 v31, 8192, v30
    v_add_u32 v32, 16384, v30
    v_add_u32 v33, 24576, v30
    v_add_u32 v34, 32768, v30
    v_add_u32 v35, 40960, v30
    v_add_u32 v36, 49152, v30
    v_add_u32 v37, 57344, v30
    s_mul_i32 s41, s45, 7
    s_add_u32 s41, s41, s40
    s_lshl_b32 s41, s41, 16
    v_subrev_u32 v40, 7, v2
    v_mul_u32_u24 v41, 43, v40
    v_lshrrev_b32 v41, 7, v41
    v_mul_u32_u24 v43, 3, v41
    v_sub_u32 v43, v40, v43
    v_subrev_u32 v44, 28, v2
    v_lshrrev_b32 v42, 2, v44
    v_and_b32 v44, 3, v44
    v_add_u32 v44, 3, v44
    v_cmp_gt_u32 vcc, 28, v2
    v_cndmask_b32 v42, v42, v41, vcc
    v_cndmask_b32 v43, v44, v43, vcc
    v_add_u32 v42, 1, v42
    v_cmp_gt_u32 vcc, 7, v2
    v_cndmask_b32 v42, v42, 0, vcc
    v_cndmask_b32 v43, v43, v2, vcc
    v_add_u32 v42, s21, v42
    v_and_b32 v42, 7, v42
    v_mul_u32_u24 v42, 7, v42
    v_add_u32 v42, v42, v43
    v_lshlrev_b32 v29, 16, v42
    s_mov_b32 s49, s40
    s_lshl_b32 s42, s40, 13
    v_lshlrev_b32 v38, 4, v2
    v_add_u32 v38, s42, v38
    v_add_u32 v39, 0x10000, v38
    s_waitcnt vmcnt(16)
    s_barrier
    s_add_u32 m0, s42, 0
    s_add_u32 s49, s49, 2
    buffer_load_dwordx4 v30, s[28:31], s41 offen lds
    s_add_u32 m0, s42, 1024
    v_readlane_b32 s46, v29, s49
    buffer_load_dwordx4 v31, s[28:31], s41 offen lds
    s_add_u32 m0, s42, 2048
    s_nop 0
    buffer_load_dwordx4 v32, s[28:31], s41 offen lds
    s_add_u32 m0, s42, 3072
    s_nop 0
    buffer_load_dwordx4 v33, s[28:31], s41 offen lds
    s_add_u32 m0, s42, 4096
    s_nop 0
    buffer_load_dwordx4 v34, s[28:31], s41 offen lds
    s_add_u32 m0, s42, 5120
    s_nop 0
    buffer_load_dwordx4 v35, s[28:31], s41 offen lds
    s_add_u32 m0, s42, 6144
    s_nop 0
    buffer_load_dwordx4 v36, s[28:31], s41 offen lds
    s_add_u32 m0, s42, 7168
    s_nop 0
    buffer_load_dwordx4 v37, s[28:31], s41 offen lds
    s_mov_b32 s41, s46
    s_add_u32 m0, s42, 16384
    s_add_u32 s49, s49, 2
    buffer_load_dwordx4 v30, s[28:31], s41 offen lds
    s_add_u32 m0, s42, 17408
    v_readlane_b32 s46, v29, s49
    buffer_load_dwordx4 v31, s[28:31], s41 offen lds
    s_add_u32 m0, s42, 18432
    s_nop 0
    buffer_load_dwordx4 v32, s[28:31], s41 offen lds
    s_add_u32 m0, s42, 19456
    s_nop 0
    buffer_load_dwordx4 v33, s[28:31], s41 offen lds
    s_add_u32 m0, s42, 20480
    s_nop 0
    buffer_load_dwordx4 v34, s[28:31], s41 offen lds
    s_add_u32 m0, s42, 21504
    s_nop 0
    buffer_load_dwordx4 v35, s[28:31], s41 offen lds
    s_add_u32 m0, s42, 22528
    s_nop 0
    buffer_load_dwordx4 v36, s[28:31], s41 offen lds
    s_add_u32 m0, s42, 23552
    s_nop 0
    buffer_load_dwordx4 v37, s[28:31], s41 offen lds
    s_mov_b32 s41, s46
    s_add_u32 m0, s42, 32768
    s_add_u32 s49, s49, 2
    buffer_load_dwordx4 v30, s[28:31], s41 offen lds
    s_add_u32 m0, s42, 33792
    v_readlane_b32 s46, v29, s49
    buffer_load_dwordx4 v31, s[28:31], s41 offen lds
    s_add_u32 m0, s42, 34816
    s_nop 0
    buffer_load_dwordx4 v32, s[28:31], s41 offen lds
    s_add_u32 m0, s42, 35840
    s_nop 0
    buffer_load_dwordx4 v33, s[28:31], s41 offen lds
    s_add_u32 m0, s42, 36864
    s_nop 0
    buffer_load_dwordx4 v34, s[28:31], s41 offen lds
    s_add_u32 m0, s42, 37888
    s_nop 0
    buffer_load_dwordx4 v35, s[28:31], s41 offen lds
    s_add_u32 m0, s42, 38912
    s_nop 0
    buffer_load_dwordx4 v36, s[28:31], s41 offen lds
    s_add_u32 m0, s42, 39936
    s_nop 0
    buffer_load_dwordx4 v37, s[28:31], s41 offen lds
    s_mov_b32 s41, s46
    s_waitcnt vmcnt(24)
    s_barrier
    s_add_u32 m0, s42, 49152
    s_add_u32 s49, s49, 2
    buffer_load_dwordx4 v30, s[28:31], s41 offen lds
    s_add_u32 m0, s42, 50176
    v_readlane_b32 s46, v29, s49
    buffer_load_dwordx4 v31, s[28:31], s41 offen lds
    s_add_u32 m0, s42, 51200
    s_nop 0
    buffer_load_dwordx4 v32, s[28:31], s41 offen lds
    s_add_u32 m0, s42, 52224
    s_nop 0
    buffer_load_dwordx4 v33, s[28:31], s41 offen lds
    s_add_u32 m0, s42, 53248
    s_nop 0
    buffer_load_dwordx4 v34, s[28:31], s41 offen lds
    s_add_u32 m0, s42, 54272
    s_nop 0
    buffer_load_dwordx4 v35, s[28:31], s41 offen lds
    s_add_u32 m0, s42, 55296
    s_nop 0
    buffer_load_dwordx4 v36, s[28:31], s41 offen lds
    s_add_u32 m0, s42, 56320
    s_nop 0
    buffer_load_dwordx4 v37, s[28:31], s41 offen lds
    s_mov_b32 s41, s46
    s_add_u32 m0, s42, 65536
    s_add_u32 s49, s49, 2
    buffer_load_dwordx4 v30, s[28:31], s41 offen lds
    s_add_u32 m0, s42, 66560
    v_readlane_b32 s46, v29, s49
    buffer_load_dwordx4 v31, s[28:31], s41 offen lds
    s_add_u32 m0, s42, 67584
    s_nop 0
    buffer_load_dwordx4 v32, s[28:31], s41 offen lds
    s_add_u32 m0, s42, 68608
    s_nop 0
    buffer_load_dwordx4 v33, s[28:31], s41 offen lds
    s_add_u32 m0, s42, 69632
    s_nop 0
    buffer_load_dwordx4 v34, s[28:31], s41 offen lds
    s_add_u32 m0, s42, 70656
    s_nop 0
    buffer_load_dwordx4 v35, s[28:31], s41 offen lds
    s_add_u32 m0, s42, 71680
    s_nop 0
    buffer_load_dwordx4 v36, s[28:31], s41 offen lds
    s_add_u32 m0, s42, 72704
    s_nop 0
    buffer_load_dwordx4 v37, s[28:31], s41 offen lds
    s_mov_b32 s41, s46
    s_add_u32 m0, s42, 81920
    s_add_u32 s49, s49, 2
    buffer_load_dwordx4 v30, s[28:31], s41 offen lds
    s_add_u32 m0, s42, 82944
    v_readlane_b32 s46, v29, s49
    buffer_load_dwordx4 v31, s[28:31], s41 offen lds
    s_add_u32 m0, s42, 83968
    s_nop 0
    buffer_load_dwordx4 v32, s[28:31], s41 offen lds
    s_add_u32 m0, s42, 84992
    s_nop 0
    buffer_load_dwordx4 v33, s[28:31], s41 offen lds
    s_add_u32 m0, s42, 86016
    s_nop 0
    buffer_load_dwordx4 v34, s[28:31], s41 offen lds
    s_add_u32 m0, s42, 87040
    s_nop 0
    buffer_load_dwordx4 v35, s[28:31], s41 offen lds
    s_add_u32 m0, s42, 88064
    s_nop 0
    buffer_load_dwordx4 v36, s[28:31], s41 offen lds
    s_add_u32 m0, s42, 89088
    s_nop 0
    buffer_load_dwordx4 v37, s[28:31], s41 offen lds
    s_mov_b32 s41, s46
    s_barrier
    s_waitcnt vmcnt(40)
    s_barrier
    s_waitcnt vmcnt(32)
    s_barrier
    s_add_u32 m0, s42, 98304
    s_add_u32 s49, s49, 2
    buffer_load_dwordx4 v30, s[28:31], s41 offen lds
    s_add_u32 m0, s42, 99328
    v_readlane_b32 s46, v29, s49
    buffer_load_dwordx4 v31, s[28:31], s41 offen lds
    s_add_u32 m0, s42, 100352
    s_nop 0
    buffer_load_dwordx4 v32, s[28:31], s41 offen lds
    s_add_u32 m0, s42, 101376
    s_nop 0
    buffer_load_dwordx4 v33, s[28:31], s41 offen lds
    s_add_u32 m0, s42, 102400
    s_nop 0
    buffer_load_dwordx4 v34, s[28:31], s41 offen lds
    s_add_u32 m0, s42, 103424
    s_nop 0
    buffer_load_dwordx4 v35, s[28:31], s41 offen lds
    s_add_u32 m0, s42, 104448
    s_nop 0
    buffer_load_dwordx4 v36, s[28:31], s41 offen lds
    s_add_u32 m0, s42, 105472
    s_nop 0
    buffer_load_dwordx4 v37, s[28:31], s41 offen lds
    s_mov_b32 s41, s46
    s_add_u32 m0, s42, 114688
    s_add_u32 s49, s49, 2
    buffer_load_dwordx4 v30, s[28:31], s41 offen lds
    s_add_u32 m0, s42, 115712
    v_readlane_b32 s46, v29, s49
    buffer_load_dwordx4 v31, s[28:31], s41 offen lds
    s_add_u32 m0, s42, 116736
    s_nop 0
    buffer_load_dwordx4 v32, s[28:31], s41 offen lds
    s_add_u32 m0, s42, 117760
    s_nop 0
    buffer_load_dwordx4 v33, s[28:31], s41 offen lds
    s_add_u32 m0, s42, 118784
    s_nop 0
    buffer_load_dwordx4 v34, s[28:31], s41 offen lds
    s_add_u32 m0, s42, 119808
    s_nop 0
    buffer_load_dwordx4 v35, s[28:31], s41 offen lds
    s_add_u32 m0, s42, 120832
    s_nop 0
    buffer_load_dwordx4 v36, s[28:31], s41 offen lds
    s_add_u32 m0, s42, 121856
    s_nop 0
    buffer_load_dwordx4 v37, s[28:31], s41 offen lds
    s_mov_b32 s41, s46
    s_add_u32 s42, s42, 0
    s_mov_b32 s47, 1
    s_waitcnt lgkmcnt(0)
L_WLOOP:
    s_waitcnt vmcnt(40)
    s_barrier
    s_add_u32 m0, s42, 0
    s_add_u32 s49, s49, 2
    buffer_load_dwordx4 v30, s[28:31], s41 offen lds
    s_add_u32 m0, s42, 1024
    v_readlane_b32 s46, v29, s49
    buffer_load_dwordx4 v31, s[28:31], s41 offen lds
    s_add_u32 m0, s42, 2048
    s_nop 0
    buffer_load_dwordx4 v32, s[28:31], s41 offen lds
    s_add_u32 m0, s42, 3072
    s_nop 0
    buffer_load_dwordx4 v33, s[28:31], s41 offen lds
    s_add_u32 m0, s42, 4096
    s_nop 0
    buffer_load_dwordx4 v34, s[28:31], s41 offen lds
    s_add_u32 m0, s42, 5120
    s_nop 0
    buffer_load_dwordx4 v35, s[28:31], s41 offen lds
    s_add_u32 m0, s42, 6144
    s_nop 0
    buffer_load_dwordx4 v36, s[28:31], s41 offen lds
    s_add_u32 m0, s42, 7168
    s_nop 0
    buffer_load_dwordx4 v37, s[28:31], s41 offen lds
    s_mov_b32 s41, s46
    s_add_u32 s42, s42, 16384
    s_and_b32 s42, s42, 0x1ffff
    s_add_u32 s47, s47, 1
    s_cmp_lt_u32 s47, 21
    s_cbranch_scc1 L_WLOOP
    s_waitcnt vmcnt(40)
    s_barrier
    s_waitcnt vmcnt(32)
    s_barrier
    s_waitcnt vmcnt(24)
    s_barrier
    s_waitcnt vmcnt(16)
    s_barrier
    s_waitcnt vmcnt(8)
    s_barrier
    s_waitcnt vmcnt(0)
    s_barrier
    s_endpgm
L_LOADA:
    v_lshrrev_b32 v3, 3, v2
    v_and_b32 v4, 7, v2
    v_xor_b32 v4, v4, v3
    v_lshlrev_b32 v4, 4, v4
    v_lshl_add_u32 v4, v3, 11, v4
    s_lshl_b32 s44, s20, 18
    s_lshl_b32 s45, s40, 17
    s_add_u32 s44, s44, s45
    v_add_u32 v8, s44, v4
    v_add_u32 v9, 16384, v8
    v_add_u32 v10, 32768, v8
    v_add_u32 v11, 49152, v8
    v_add_u32 v12, 65536, v8
    v_add_u32 v13, 81920, v8
    v_add_u32 v14, 98304, v8
    v_add_u32 v15, 114688, v8
    s_lshl_b32 s41, s41, 7
    s_lshl_b32 s42, s40, 13
    s_waitcnt lgkmcnt(0)
    s_mov_b32 s24, s4
    s_and_b32 s25, s5, 0xffff
    s_mov_b32 s26, 4194304
    s_mov_b32 s27, 0x20000
    s_mov_b32 s36, s16
    s_and_b32 s37, s17, 0xffff
    s_mov_b32 s38, 256
    s_mov_b32 s39, 0x20000
    s_mov_b32 s56, s18
    s_and_b32 s57, s19, 0xffff
    s_mov_b32 s58, 67108864
    s_mov_b32 s59, 0x20000
    s_lshl_b32 s60, s20, 4
    s_add_u32 s61, s60, s21
    s_lshl_b32 s62, s61, 10
    s_add_u32 s62, s62, 50331648
    v_lshlrev_b32 v40, 3, v2
    s_lshl_b32 s63, s40, 9
    s_add_u32 s63, s63, s62
    v_mov_b32 v42, 0
    v_mov_b32 v43, 0
    v_mov_b32 v44, 1
    buffer_store_dwordx2 v[42:43], v40, s[56:59], s63 offen sc1
    v_mov_b32 v41, 160000
    ds_write_b32 v41, v42
    s_waitcnt lgkmcnt(0)
    s_add_u32 m0, s42, 98304
    s_add_u32 s46, s41, 128
    buffer_load_dwordx4 v8, s[24:27], s41 offen lds
    s_add_u32 m0, s42, 99328
    s_and_b32 s46, s46, 2047
    buffer_load_dwordx4 v9, s[24:27], s41 offen lds
    s_add_u32 m0, s42, 100352
    s_nop 0
    buffer_load_dwordx4 v10, s[24:27], s41 offen lds
    s_add_u32 m0, s42, 101376
    s_nop 0
    buffer_load_dwordx4 v11, s[24:27], s41 offen lds
    s_add_u32 m0, s42, 102400
    s_nop 0
    buffer_load_dwordx4 v12, s[24:27], s41 offen lds
    s_add_u32 m0, s42, 103424
    s_nop 0
    buffer_load_dwordx4 v13, s[24:27], s41 offen lds
    s_add_u32 m0, s42, 104448
    s_nop 0
    buffer_load_dwordx4 v14, s[24:27], s41 offen lds
    s_add_u32 m0, s42, 105472
    s_nop 0
    buffer_load_dwordx4 v15, s[24:27], s41 offen lds
    s_mov_b32 s41, s46
    s_add_u32 m0, s42, 0
    s_add_u32 s46, s41, 128
    buffer_load_dwordx4 v8, s[24:27], s41 offen lds
    s_add_u32 m0, s42, 1024
    s_and_b32 s46, s46, 2047
    buffer_load_dwordx4 v9, s[24:27], s41 offen lds
    s_add_u32 m0, s42, 2048
    s_nop 0
    buffer_load_dwordx4 v10, s[24:27], s41 offen lds
    s_add_u32 m0, s42, 3072
    s_nop 0
    buffer_load_dwordx4 v11, s[24:27], s41 offen lds
    s_add_u32 m0, s42, 4096
    s_nop 0
    buffer_load_dwordx4 v12, s[24:27], s41 offen lds
    s_add_u32 m0, s42, 5120
    s_nop 0
    buffer_load_dwordx4 v13, s[24:27], s41 offen lds
    s_add_u32 m0, s42, 6144
    s_nop 0
    buffer_load_dwordx4 v14, s[24:27], s41 offen lds
    s_add_u32 m0, s42, 7168
    s_nop 0
    buffer_load_dwordx4 v15, s[24:27], s41 offen lds
    s_mov_b32 s41, s46
    s_waitcnt vmcnt(8)
    s_barrier
    s_add_u32 m0, s42, 49152
    s_add_u32 s46, s41, 128
    buffer_load_dwordx4 v8, s[24:27], s41 offen lds
    s_add_u32 m0, s42, 50176
    s_and_b32 s46, s46, 2047
    buffer_load_dwordx4 v9, s[24:27], s41 offen lds
    s_add_u32 m0, s42, 51200
    s_nop 0
    buffer_load_dwordx4 v10, s[24:27], s41 offen lds
    s_add_u32 m0, s42, 52224
    s_nop 0
    buffer_load_dwordx4 v11, s[24:27], s41 offen lds
    s_add_u32 m0, s42, 53248
    s_nop 0
    buffer_load_dwordx4 v12, s[24:27], s41 offen lds
    s_add_u32 m0, s42, 54272
    s_nop 0
    buffer_load_dwordx4 v13, s[24:27], s41 offen lds
    s_add_u32 m0, s42, 55296
    s_nop 0
    buffer_load_dwordx4 v14, s[24:27], s41 offen lds
    s_add_u32 m0, s42, 56320
    s_nop 0
    buffer_load_dwordx4 v15, s[24:27], s41 offen lds
    s_mov_b32 s41, s46
    s_waitcnt vmcnt(8)
    s_barrier
    s_add_u32 m0, s42, 98304
    s_add_u32 s46, s41, 128
    buffer_load_dwordx4 v8, s[24:27], s41 offen lds
    s_add_u32 m0, s42, 99328
    s_and_b32 s46, s46, 2047
    buffer_load_dwordx4 v9, s[24:27], s41 offen lds
    s_add_u32 m0, s42, 100352
    s_nop 0
    buffer_load_dwordx4 v10, s[24:27], s41 offen lds
    s_add_u32 m0, s42, 101376
    s_nop 0
    buffer_load_dwordx4 v11, s[24:27], s41 offen lds
    s_add_u32 m0, s42, 102400
    s_nop 0
    buffer_load_dwordx4 v12, s[24:27], s41 offen lds
    s_add_u32 m0, s42, 103424
    s_nop 0
    buffer_load_dwordx4 v13, s[24:27], s41 offen lds
    s_add_u32 m0, s42, 104448
    s_nop 0
    buffer_load_dwordx4 v14, s[24:27], s41 offen lds
    s_add_u32 m0, s42, 105472
    s_nop 0
    buffer_load_dwordx4 v15, s[24:27], s41 offen lds
    s_mov_b32 s41, s46
    s_waitcnt vmcnt(8)
    s_barrier
    s_add_u32 m0, s42, 0
    s_add_u32 s46, s41, 128
    buffer_load_dwordx4 v8, s[24:27], s41 offen lds
    s_add_u32 m0, s42, 1024
    s_and_b32 s46, s46, 2047
    buffer_load_dwordx4 v9, s[24:27], s41 offen lds
    s_add_u32 m0, s42, 2048
    s_nop 0
    buffer_load_dwordx4 v10, s[24:27], s41 offen lds
    s_add_u32 m0, s42, 3072
    s_nop 0
    buffer_load_dwordx4 v11, s[24:27], s41 offen lds
    s_add_u32 m0, s42, 4096
    s_nop 0
    buffer_load_dwordx4 v12, s[24:27], s41 offen lds
    s_add_u32 m0, s42, 5120
    s_nop 0
    buffer_load_dwordx4 v13, s[24:27], s41 offen lds
    s_add_u32 m0, s42, 6144
    s_nop 0
    buffer_load_dwordx4 v14, s[24:27], s41 offen lds
    s_add_u32 m0, s42, 7168
    s_nop 0
    buffer_load_dwordx4 v15, s[24:27], s41 offen lds
    s_mov_b32 s41, s46
    s_waitcnt vmcnt(8)
    s_barrier
    s_add_u32 m0, s42, 49152
    s_add_u32 s46, s41, 128
    buffer_load_dwordx4 v8, s[24:27], s41 offen lds
    s_add_u32 m0, s42, 50176
    s_and_b32 s46, s46, 2047
    buffer_load_dwordx4 v9, s[24:27], s41 offen lds
    s_add_u32 m0, s42, 51200
    s_nop 0
    buffer_load_dwordx4 v10, s[24:27], s41 offen lds
    s_add_u32 m0, s42, 52224
    s_nop 0
    buffer_load_dwordx4 v11, s[24:27], s41 offen lds
    s_add_u32 m0, s42, 53248
    s_nop 0
    buffer_load_dwordx4 v12, s[24:27], s41 offen lds
    s_add_u32 m0, s42, 54272
    s_nop 0
    buffer_load_dwordx4 v13, s[24:27], s41 offen lds
    s_add_u32 m0, s42, 55296
    s_nop 0
    buffer_load_dwordx4 v14, s[24:27], s41 offen lds
    s_add_u32 m0, s42, 56320
    s_nop 0
    buffer_load_dwordx4 v15, s[24:27], s41 offen lds
    s_mov_b32 s41, s46
    s_waitcnt vmcnt(8)
    s_barrier
    s_add_u32 m0, s42, 98304
    s_add_u32 s46, s41, 128
    buffer_load_dwordx4 v8, s[24:27], s41 offen lds
    s_add_u32 m0, s42, 99328
    s_and_b32 s46, s46, 2047
    buffer_load_dwordx4 v9, s[24:27], s41 offen lds
    s_add_u32 m0, s42, 100352
    s_nop 0
    buffer_load_dwordx4 v10, s[24:27], s41 offen lds
    s_add_u32 m0, s42, 101376
    s_nop 0
    buffer_load_dwordx4 v11, s[24:27], s41 offen lds
    s_add_u32 m0, s42, 102400
    s_nop 0
    buffer_load_dwordx4 v12, s[24:27], s41 offen lds
    s_add_u32 m0, s42, 103424
    s_nop 0
    buffer_load_dwordx4 v13, s[24:27], s41 offen lds
    s_add_u32 m0, s42, 104448
    s_nop 0
    buffer_load_dwordx4 v14, s[24:27], s41 offen lds
    s_add_u32 m0, s42, 105472
    s_nop 0
    buffer_load_dwordx4 v15, s[24:27], s41 offen lds
    s_mov_b32 s41, s46
    s_waitcnt vmcnt(8)
    s_barrier
    s_add_u32 m0, s42, 0
    s_add_u32 s46, s41, 128
    buffer_load_dwordx4 v8, s[24:27], s41 offen lds
    s_add_u32 m0, s42, 1024
    s_and_b32 s46, s46, 2047
    buffer_load_dwordx4 v9, s[24:27], s41 offen lds
    s_add_u32 m0, s42, 2048
    s_nop 0
    buffer_load_dwordx4 v10, s[24:27], s41 offen lds
    s_add_u32 m0, s42, 3072
    s_nop 0
    buffer_load_dwordx4 v11, s[24:27], s41 offen lds
    s_add_u32 m0, s42, 4096
    s_nop 0
    buffer_load_dwordx4 v12, s[24:27], s41 offen lds
    s_add_u32 m0, s42, 5120
    s_nop 0
    buffer_load_dwordx4 v13, s[24:27], s41 offen lds
    s_add_u32 m0, s42, 6144
    s_nop 0
    buffer_load_dwordx4 v14, s[24:27], s41 offen lds
    s_add_u32 m0, s42, 7168
    s_nop 0
    buffer_load_dwordx4 v15, s[24:27], s41 offen lds
    s_mov_b32 s41, s46
    s_waitcnt vmcnt(8)
    s_barrier
    s_add_u32 m0, s42, 49152
    s_add_u32 s46, s41, 128
    buffer_load_dwordx4 v8, s[24:27], s41 offen lds
    s_add_u32 m0, s42, 50176
    s_and_b32 s46, s46, 2047
    buffer_load_dwordx4 v9, s[24:27], s41 offen lds
    s_add_u32 m0, s42, 51200
    s_nop 0
    buffer_load_dwordx4 v10, s[24:27], s41 offen lds
    s_add_u32 m0, s42, 52224
    s_nop 0
    buffer_load_dwordx4 v11, s[24:27], s41 offen lds
    s_add_u32 m0, s42, 53248
    s_nop 0
    buffer_load_dwordx4 v12, s[24:27], s41 offen lds
    s_add_u32 m0, s42, 54272
    s_nop 0
    buffer_load_dwordx4 v13, s[24:27], s41 offen lds
    s_add_u32 m0, s42, 55296
    s_nop 0
    buffer_load_dwordx4 v14, s[24:27], s41 offen lds
    s_add_u32 m0, s42, 56320
    s_nop 0
    buffer_load_dwordx4 v15, s[24:27], s41 offen lds
    s_mov_b32 s41, s46
    s_waitcnt vmcnt(8)
    s_barrier
    s_add_u32 m0, s42, 98304
    s_add_u32 s46, s41, 128
    buffer_load_dwordx4 v8, s[24:27], s41 offen lds
    s_add_u32 m0, s42, 99328
    s_and_b32 s46, s46, 2047
    buffer_load_dwordx4 v9, s[24:27], s41 offen lds
    s_add_u32 m0, s42, 100352
    s_nop 0
    buffer_load_dwordx4 v10, s[24:27], s41 offen lds
    s_add_u32 m0, s42, 101376
    s_nop 0
    buffer_load_dwordx4 v11, s[24:27], s41 offen lds
    s_add_u32 m0, s42, 102400
    s_nop 0
    buffer_load_dwordx4 v12, s[24:27], s41 offen lds
    s_add_u32 m0, s42, 103424
    s_nop 0
    buffer_load_dwordx4 v13, s[24:27], s41 offen lds
    s_add_u32 m0, s42, 104448
    s_nop 0
    buffer_load_dwordx4 v14, s[24:27], s41 offen lds
    s_add_u32 m0, s42, 105472
    s_nop 0
    buffer_load_dwordx4 v15, s[24:27], s41 offen lds
    s_mov_b32 s41, s46
    s_waitcnt vmcnt(8)
    s_barrier
    s_add_u32 m0, s42, 0
    s_add_u32 s46, s41, 128
    buffer_load_dwordx4 v8, s[24:27], s41 offen lds
    s_add_u32 m0, s42, 1024
    s_and_b32 s46, s46, 2047
    buffer_load_dwordx4 v9, s[24:27], s41 offen lds
    s_add_u32 m0, s42, 2048
    s_nop 0
    buffer_load_dwordx4 v10, s[24:27], s41 offen lds
    s_add_u32 m0, s42, 3072
    s_nop 0
    buffer_load_dwordx4 v11, s[24:27], s41 offen lds
    s_add_u32 m0, s42, 4096
    s_nop 0
    buffer_load_dwordx4 v12, s[24:27], s41 offen lds
    s_add_u32 m0, s42, 5120
    s_nop 0
    buffer_load_dwordx4 v13, s[24:27], s41 offen lds
    s_add_u32 m0, s42, 6144
    s_nop 0
    buffer_load_dwordx4 v14, s[24:27], s41 offen lds
    s_add_u32 m0, s42, 7168
    s_nop 0
    buffer_load_dwordx4 v15, s[24:27], s41 offen lds
    s_mov_b32 s41, s46
    s_waitcnt vmcnt(8)
    s_barrier
    s_add_u32 m0, s42, 49152
    s_add_u32 s46, s41, 128
    buffer_load_dwordx4 v8, s[24:27], s41 offen lds
    s_add_u32 m0, s42, 50176
    s_and_b32 s46, s46, 2047
    buffer_load_dwordx4 v9, s[24:27], s41 offen lds
    s_add_u32 m0, s42, 51200
    s_nop 0
    buffer_load_dwordx4 v10, s[24:27], s41 offen lds
    s_add_u32 m0, s42, 52224
    s_nop 0
    buffer_load_dwordx4 v11, s[24:27], s41 offen lds
    s_add_u32 m0, s42, 53248
    s_nop 0
    buffer_load_dwordx4 v12, s[24:27], s41 offen lds
    s_add_u32 m0, s42, 54272
    s_nop 0
    buffer_load_dwordx4 v13, s[24:27], s41 offen lds
    s_add_u32 m0, s42, 55296
    s_nop 0
    buffer_load_dwordx4 v14, s[24:27], s41 offen lds
    s_add_u32 m0, s42, 56320
    s_nop 0
    buffer_load_dwordx4 v15, s[24:27], s41 offen lds
    s_mov_b32 s41, s46
    s_waitcnt vmcnt(8)
    s_barrier
    s_add_u32 m0, s42, 98304
    s_add_u32 s46, s41, 128
    buffer_load_dwordx4 v8, s[24:27], s41 offen lds
    s_add_u32 m0, s42, 99328
    s_and_b32 s46, s46, 2047
    buffer_load_dwordx4 v9, s[24:27], s41 offen lds
    s_add_u32 m0, s42, 100352
    s_nop 0
    buffer_load_dwordx4 v10, s[24:27], s41 offen lds
    s_add_u32 m0, s42, 101376
    s_nop 0
    buffer_load_dwordx4 v11, s[24:27], s41 offen lds
    s_add_u32 m0, s42, 102400
    s_nop 0
    buffer_load_dwordx4 v12, s[24:27], s41 offen lds
    s_add_u32 m0, s42, 103424
    s_nop 0
    buffer_load_dwordx4 v13, s[24:27], s41 offen lds
    s_add_u32 m0, s42, 104448
    s_nop 0
    buffer_load_dwordx4 v14, s[24:27], s41 offen lds
    s_add_u32 m0, s42, 105472
    s_nop 0
    buffer_load_dwordx4 v15, s[24:27], s41 offen lds
    s_mov_b32 s41, s46
    s_waitcnt vmcnt(8)
    s_barrier
    s_add_u32 m0, s42, 0
    s_add_u32 s46, s41, 128
    buffer_load_dwordx4 v8, s[24:27], s41 offen lds
    s_add_u32 m0, s42, 1024
    s_and_b32 s46, s46, 2047
    buffer_load_dwordx4 v9, s[24:27], s41 offen lds
    s_add_u32 m0, s42, 2048
    s_nop 0
    buffer_load_dwordx4 v10, s[24:27], s41 offen lds
    s_add_u32 m0, s42, 3072
    s_nop 0
    buffer_load_dwordx4 v11, s[24:27], s41 offen lds
    s_add_u32 m0, s42, 4096
    s_nop 0
    buffer_load_dwordx4 v12, s[24:27], s41 offen lds
    s_add_u32 m0, s42, 5120
    s_nop 0
    buffer_load_dwordx4 v13, s[24:27], s41 offen lds
    s_add_u32 m0, s42, 6144
    s_nop 0
    buffer_load_dwordx4 v14, s[24:27], s41 offen lds
    s_add_u32 m0, s42, 7168
    s_nop 0
    buffer_load_dwordx4 v15, s[24:27], s41 offen lds
    s_mov_b32 s41, s46
    s_waitcnt vmcnt(8)
    s_barrier
    s_add_u32 m0, s42, 49152
    s_add_u32 s46, s41, 128
    buffer_load_dwordx4 v8, s[24:27], s41 offen lds
    s_add_u32 m0, s42, 50176
    s_and_b32 s46, s46, 2047
    buffer_load_dwordx4 v9, s[24:27], s41 offen lds
    s_add_u32 m0, s42, 51200
    s_nop 0
    buffer_load_dwordx4 v10, s[24:27], s41 offen lds
    s_add_u32 m0, s42, 52224
    s_nop 0
    buffer_load_dwordx4 v11, s[24:27], s41 offen lds
    s_add_u32 m0, s42, 53248
    s_nop 0
    buffer_load_dwordx4 v12, s[24:27], s41 offen lds
    s_add_u32 m0, s42, 54272
    s_nop 0
    buffer_load_dwordx4 v13, s[24:27], s41 offen lds
    s_add_u32 m0, s42, 55296
    s_nop 0
    buffer_load_dwordx4 v14, s[24:27], s41 offen lds
    s_add_u32 m0, s42, 56320
    s_nop 0
    buffer_load_dwordx4 v15, s[24:27], s41 offen lds
    s_mov_b32 s41, s46
    s_waitcnt vmcnt(8)
    s_barrier
    s_add_u32 m0, s42, 98304
    s_add_u32 s46, s41, 128
    buffer_load_dwordx4 v8, s[24:27], s41 offen lds
    s_add_u32 m0, s42, 99328
    s_and_b32 s46, s46, 2047
    buffer_load_dwordx4 v9, s[24:27], s41 offen lds
    s_add_u32 m0, s42, 100352
    s_nop 0
    buffer_load_dwordx4 v10, s[24:27], s41 offen lds
    s_add_u32 m0, s42, 101376
    s_nop 0
    buffer_load_dwordx4 v11, s[24:27], s41 offen lds
    s_add_u32 m0, s42, 102400
    s_nop 0
    buffer_load_dwordx4 v12, s[24:27], s41 offen lds
    s_add_u32 m0, s42, 103424
    s_nop 0
    buffer_load_dwordx4 v13, s[24:27], s41 offen lds
    s_add_u32 m0, s42, 104448
    s_nop 0
    buffer_load_dwordx4 v14, s[24:27], s41 offen lds
    s_add_u32 m0, s42, 105472
    s_nop 0
    buffer_load_dwordx4 v15, s[24:27], s41 offen lds
    s_mov_b32 s41, s46
    s_waitcnt vmcnt(8)
    s_barrier
    s_waitcnt vmcnt(0)
    s_barrier
    s_barrier
    s_cmp_eq_u32 s40, 1
    s_cbranch_scc1 L_AEND
    s_mov_b32 s51, 40000
    s_mov_b32 s52, 16
    v_lshlrev_b32 v3, 2, v2
    s_mov_b64 exec, 1
L_MARK:
    buffer_load_dword v6, v3, s[36:39], s60 offen sc1
    s_sub_u32 s51, s51, 1
    s_waitcnt vmcnt(0)
    v_cmp_gt_u32 vcc, s52, v6
    s_cbranch_vccz L_MARKD
    s_cmp_lg_u32 s51, 0
    s_cbranch_scc1 L_MARK
L_MARKD:
    s_mov_b64 exec, 0xffff
    s_and_b32 s47, s21, 7
    v_sub_u32 v5, s47, v2
    v_and_b32 v5, 7, v5
    v_lshlrev_b32 v5, 2, v5
    v_lshl_add_u32 v5, v2, 10, v5
    s_and_b32 s46, s61, 0xf8
    s_lshl_b32 s46, s46, 10
    s_add_u32 s46, s46, 50331648
    s_mov_b32 s48, 0
    s_barrier
    s_barrier
    s_mov_b32 s51, 40000
L_POLL0:
    s_bitcmp1_b32 s48, 1
    s_cbranch_scc1 L_POLLD0
    buffer_load_dword v6, v3, s[56:59], s62 offen sc1
    s_sub_u32 s51, s51, 1
    s_waitcnt vmcnt(0)
    v_cmp_eq_u32 vcc, 1, v6
    s_mov_b32 s48, vcc_lo
    s_cmp_lg_u32 s51, 0
    s_cbranch_scc1 L_POLL0
L_POLLD0:
    s_mov_b32 s51, 40000
L_POLL1:
    s_bitcmp1_b32 s48, 2
    s_cbranch_scc1 L_POLLD1
    buffer_load_dword v6, v3, s[56:59], s62 offen sc1
    s_sub_u32 s51, s51, 1
    s_waitcnt vmcnt(0)
    v_cmp_eq_u32 vcc, 1, v6
    s_mov_b32 s48, vcc_lo
    s_cmp_lg_u32 s51, 0
    s_cbranch_scc1 L_POLL1
L_POLLD1:
    s_barrier
    s_mov_b32 s51, 40000
L_POLL2:
    s_bitcmp1_b32 s48, 3
    s_cbranch_scc1 L_POLLD2
    buffer_load_dword v6, v3, s[56:59], s62 offen sc1
    s_sub_u32 s51, s51, 1
    s_waitcnt vmcnt(0)
    v_cmp_eq_u32 vcc, 1, v6
    s_mov_b32 s48, vcc_lo
    s_cmp_lg_u32 s51, 0
    s_cbranch_scc1 L_POLL2
L_POLLD2:
    s_barrier
    s_mov_b32 s51, 40000
L_POLL3:
    s_bitcmp1_b32 s48, 4
    s_cbranch_scc1 L_POLLD3
    buffer_load_dword v6, v3, s[56:59], s62 offen sc1
    s_sub_u32 s51, s51, 1
    s_waitcnt vmcnt(0)
    v_cmp_eq_u32 vcc, 1, v6
    s_mov_b32 s48, vcc_lo
    s_cmp_lg_u32 s51, 0
    s_cbranch_scc1 L_POLL3
L_POLLD3:
    s_barrier
    s_barrier
    s_mov_b32 s51, 40000
L_POLL4:
    s_bitcmp1_b32 s48, 5
    s_cbranch_scc1 L_POLLD4
    buffer_load_dword v6, v3, s[56:59], s62 offen sc1
    s_sub_u32 s51, s51, 1
    s_waitcnt vmcnt(0)
    v_cmp_eq_u32 vcc, 1, v6
    s_mov_b32 s48, vcc_lo
    s_cmp_lg_u32 s51, 0
    s_cbranch_scc1 L_POLL4
L_POLLD4:
    s_barrier
    s_mov_b32 s51, 40000
L_POLL5:
    s_bitcmp1_b32 s48, 6
    s_cbranch_scc1 L_POLLD5
    buffer_load_dword v6, v3, s[56:59], s62 offen sc1
    s_sub_u32 s51, s51, 1
    s_waitcnt vmcnt(0)
    v_cmp_eq_u32 vcc, 1, v6
    s_mov_b32 s48, vcc_lo
    s_cmp_lg_u32 s51, 0
    s_cbranch_scc1 L_POLL5
L_POLLD5:
    s_barrier
    s_barrier
    s_mov_b32 s51, 40000
L_POLL6:
    s_bitcmp1_b32 s48, 7
    s_cbranch_scc1 L_POLLD6
    buffer_load_dword v6, v3, s[56:59], s62 offen sc1
    s_sub_u32 s51, s51, 1
    s_waitcnt vmcnt(0)
    v_cmp_eq_u32 vcc, 1, v6
    s_mov_b32 s48, vcc_lo
    s_cmp_lg_u32 s51, 0
    s_cbranch_scc1 L_POLL6
L_POLLD6:
    s_barrier
    s_mov_b32 s51, 40000
L_POLL7:
    s_bitcmp1_b32 s48, 9
    s_cbranch_scc1 L_POLLD7
    buffer_load_dword v6, v3, s[56:59], s62 offen sc1
    s_sub_u32 s51, s51, 1
    s_waitcnt vmcnt(0)
    v_cmp_eq_u32 vcc, 1, v6
    s_mov_b32 s48, vcc_lo
    s_cmp_lg_u32 s51, 0
    s_cbranch_scc1 L_POLL7
L_POLLD7:
    s_barrier
    s_barrier
    s_mov_b32 s51, 40000
L_POLL8:
    s_bitcmp1_b32 s48, 10
    s_cbranch_scc1 L_POLLD8
    buffer_load_dword v6, v3, s[56:59], s62 offen sc1
    s_sub_u32 s51, s51, 1
    s_waitcnt vmcnt(0)
    v_cmp_eq_u32 vcc, 1, v6
    s_mov_b32 s48, vcc_lo
    s_cmp_lg_u32 s51, 0
    s_cbranch_scc1 L_POLL8
L_POLLD8:
    s_barrier
    s_barrier
    s_mov_b32 s51, 40000
L_POLL9:
    s_bitcmp1_b32 s48, 11
    s_cbranch_scc1 L_POLLD9
    buffer_load_dword v6, v3, s[56:59], s62 offen sc1
    s_sub_u32 s51, s51, 1
    s_waitcnt vmcnt(0)
    v_cmp_eq_u32 vcc, 1, v6
    s_mov_b32 s48, vcc_lo
    s_cmp_lg_u32 s51, 0
    s_cbranch_scc1 L_POLL9
L_POLLD9:
    s_barrier
    s_barrier
    s_mov_b32 s51, 40000
L_POLL10:
    s_bitcmp1_b32 s48, 12
    s_cbranch_scc1 L_POLLD10
    buffer_load_dword v6, v3, s[56:59], s62 offen sc1
    s_sub_u32 s51, s51, 1
    s_waitcnt vmcnt(0)
    v_cmp_eq_u32 vcc, 1, v6
    s_mov_b32 s48, vcc_lo
    s_cmp_lg_u32 s51, 0
    s_cbranch_scc1 L_POLL10
L_POLLD10:
    s_barrier
    s_barrier
    s_mov_b32 s51, 40000
L_POLL11:
    s_bitcmp1_b32 s48, 13
    s_cbranch_scc1 L_POLLD11
    buffer_load_dword v6, v3, s[56:59], s62 offen sc1
    s_sub_u32 s51, s51, 1
    s_waitcnt vmcnt(0)
    v_cmp_eq_u32 vcc, 1, v6
    s_mov_b32 s48, vcc_lo
    s_cmp_lg_u32 s51, 0
    s_cbranch_scc1 L_POLL11
L_POLLD11:
    s_barrier
    s_barrier
    s_mov_b32 s51, 40000
L_POLL12:
    s_bitcmp1_b32 s48, 14
    s_cbranch_scc1 L_POLLD12
    buffer_load_dword v6, v3, s[56:59], s62 offen sc1
    s_sub_u32 s51, s51, 1
    s_waitcnt vmcnt(0)
    v_cmp_eq_u32 vcc, 1, v6
    s_mov_b32 s48, vcc_lo
    s_cmp_lg_u32 s51, 0
    s_cbranch_scc1 L_POLL12
L_POLLD12:
    s_barrier
    s_barrier
    s_mov_b32 s51, 40000
L_POLL13:
    s_bitcmp1_b32 s48, 15
    s_cbranch_scc1 L_POLLD13
    buffer_load_dword v6, v3, s[56:59], s62 offen sc1
    s_sub_u32 s51, s51, 1
    s_waitcnt vmcnt(0)
    v_cmp_eq_u32 vcc, 1, v6
    s_mov_b32 s48, vcc_lo
    s_cmp_lg_u32 s51, 0
    s_cbranch_scc1 L_POLL13
L_POLLD13:
L_AEND:
    s_waitcnt vmcnt(0) lgkmcnt(0)
    s_endpgm
L_COMP:
    s_getpc_b64 s[56:57]
L_PC:
    s_sub_u32 s56, s56, L_PC-standalone__dense_activation_gelu__prompt_kernel
    s_subb_u32 s57, s57, 0
    s_lshl_b32 s58, s23, 10
    s_lshl_b32 s59, s3, 8
    s_add_u32 s58, s58, s59
    s_min_u32 s59, s58, L_END-standalone__dense_activation_gelu__prompt_kernel-192
    s_add_u32 s68, s56, s59
    s_addc_u32 s69, s57, 0
    s_load_dword s96, s[68:69], 0
    s_load_dword s96, s[68:69], 64
    s_load_dword s96, s[68:69], 128
    s_load_dword s96, s[68:69], 192
    s_add_u32 s58, s58, 32768
    s_and_b32 s40, s3, 1
    s_lshr_b32 s41, s3, 1
    v_and_b32 v12, 15, v2
    v_lshrrev_b32 v13, 4, v2
    s_mul_i32 s42, s21, 448
    s_lshl_b32 s43, s41, 4
    s_add_u32 s43, s43, s42
    s_lshl_b32 s44, s41, 6
    s_add_u32 s42, s42, s44
    v_lshlrev_b32 v14, 3, v13
    v_and_b32 v17, 32, v2
    v_and_b32 v16, 8, v14
    v_or_b32 v17, v17, v16
    s_lshl_b32 s62, s20, 4
    s_add_u32 s62, s62, s21
    s_lshl_b32 s62, s62, 2
    s_add_u32 s62, s62, s3
    s_lshr_b32 s63, s62, 2
    s_lshl_b32 s63, s63, 3
    s_add_u32 s63, s63, s3
    s_lshl_b32 s63, s63, 7
    s_add_u32 s63, s63, 50331776
    s_waitcnt lgkmcnt(0)
    s_mov_b32 s28, s8
    s_and_b32 s29, s9, 0xffff
    s_mov_b32 s30, 7168
    s_mov_b32 s31, 0x20000
    buffer_load_dwordx2 v[76:77], v14, s[28:31], s42 offen offset:64
    buffer_load_dwordx2 v[78:79], v14, s[28:31], s42 offen offset:96
    buffer_load_dwordx2 v[80:81], v14, s[28:31], s42 offen offset:192
    buffer_load_dwordx2 v[82:83], v14, s[28:31], s42 offen offset:224
    buffer_load_dwordx2 v[84:85], v14, s[28:31], s42 offen offset:320
    buffer_load_dwordx2 v[86:87], v14, s[28:31], s42 offen offset:352
    buffer_load_dwordx2 v[88:89], v17, s[28:31], s43 offen offset:0
    s_mov_b32 s32, s18
    s_and_b32 s33, s19, 0xffff
    s_mov_b32 s34, 67108864
    s_mov_b32 s35, 0x20000
    v_and_b32 v15, 7, v12
    v_xor_b32 v15, v15, v13
    v_lshlrev_b32 v15, 4, v15
    v_lshl_add_u32 v15, v12, 7, v15
    s_lshl_b32 s43, s40, 13
    s_add_u32 s43, s43, 98304
    v_add_u32 v4, s43, v15
    v_xor_b32 v5, 64, v4
    v_lshlrev_b32 v15, 12, v13
    v_bfe_u32 v16, v2, 2, 2
    v_lshl_add_u32 v15, v16, 6, v15
    v_and_b32 v16, 3, v2
    v_lshl_add_u32 v15, v16, 3, v15
    v_and_b32 v16, 1, v13
    v_lshl_add_u32 v15, v16, 5, v15
    s_lshl_b32 s44, s41, 8
    s_add_u32 s44, s44, 114688
    v_add_u32 v6, s44, v15
    v_xor_b32 v7, 32, v6
    v_and_b32 v16, 2, v2
    v_mul_u32_u24 v16, 24, v16
    v_xor_b32 v15, v16, v15
    s_lshl_b32 s44, s41, 4
    s_add_u32 s44, s44, 114688
    v_add_u32 v8, s44, v15
    v_subrev_u32 v26, 7, v2
    v_mul_u32_u24 v27, 43, v26
    v_lshrrev_b32 v27, 7, v27
    v_mul_u32_u24 v29, 3, v27
    v_sub_u32 v29, v26, v29
    v_subrev_u32 v30, 28, v2
    v_lshrrev_b32 v28, 2, v30
    v_and_b32 v30, 3, v30
    v_add_u32 v30, 3, v30
    v_cmp_gt_u32 vcc, 28, v2
    v_cndmask_b32 v28, v28, v27, vcc
    v_cndmask_b32 v29, v30, v29, vcc
    v_add_u32 v28, 1, v28
    v_cmp_gt_u32 vcc, 7, v2
    v_cndmask_b32 v28, v28, 0, vcc
    v_cndmask_b32 v29, v29, v2, vcc
    v_add_u32 v28, s21, v28
    v_and_b32 v28, 7, v28
    v_mul_u32_u24 v28, 7, v28
    v_add_u32 v28, v28, v29
    v_lshlrev_b32 v25, 13, v28
    s_lshr_b32 s45, s21, 3
    s_mul_i32 s44, s20, 112
    s_mul_i32 s45, s45, 56
    s_add_u32 s44, s44, s45
    s_lshl_b32 s44, s44, 13
    v_add_u32 v25, s44, v25
    s_mov_b32 s61, 98304
    s_mov_b32 s60, 0
    s_waitcnt vmcnt(0)
    v_lshlrev_b32 v128, 16, v76
    v_and_b32 v129, 0xffff0000, v76
    v_lshlrev_b32 v130, 16, v77
    v_and_b32 v131, 0xffff0000, v77
    v_pk_mov_b32 v[132:133], v[128:129], v[128:129] op_sel:[0,1]
    v_pk_mov_b32 v[134:135], v[130:131], v[130:131] op_sel:[0,1]
    v_pk_mov_b32 v[136:137], v[128:129], v[128:129] op_sel:[0,1]
    v_pk_mov_b32 v[138:139], v[130:131], v[130:131] op_sel:[0,1]
    v_pk_mov_b32 v[140:141], v[128:129], v[128:129] op_sel:[0,1]
    v_pk_mov_b32 v[142:143], v[130:131], v[130:131] op_sel:[0,1]
    v_lshlrev_b32 v144, 16, v78
    v_and_b32 v145, 0xffff0000, v78
    v_lshlrev_b32 v146, 16, v79
    v_and_b32 v147, 0xffff0000, v79
    v_pk_mov_b32 v[148:149], v[144:145], v[144:145] op_sel:[0,1]
    v_pk_mov_b32 v[150:151], v[146:147], v[146:147] op_sel:[0,1]
    v_pk_mov_b32 v[152:153], v[144:145], v[144:145] op_sel:[0,1]
    v_pk_mov_b32 v[154:155], v[146:147], v[146:147] op_sel:[0,1]
    v_pk_mov_b32 v[156:157], v[144:145], v[144:145] op_sel:[0,1]
    v_pk_mov_b32 v[158:159], v[146:147], v[146:147] op_sel:[0,1]
    v_lshlrev_b32 v160, 16, v80
    v_and_b32 v161, 0xffff0000, v80
    v_lshlrev_b32 v162, 16, v81
    v_and_b32 v163, 0xffff0000, v81
    v_pk_mov_b32 v[164:165], v[160:161], v[160:161] op_sel:[0,1]
    v_pk_mov_b32 v[166:167], v[162:163], v[162:163] op_sel:[0,1]
    v_pk_mov_b32 v[168:169], v[160:161], v[160:161] op_sel:[0,1]
    v_pk_mov_b32 v[170:171], v[162:163], v[162:163] op_sel:[0,1]
    v_pk_mov_b32 v[172:173], v[160:161], v[160:161] op_sel:[0,1]
    v_pk_mov_b32 v[174:175], v[162:163], v[162:163] op_sel:[0,1]
    v_lshlrev_b32 v176, 16, v82
    v_and_b32 v177, 0xffff0000, v82
    v_lshlrev_b32 v178, 16, v83
    v_and_b32 v179, 0xffff0000, v83
    v_pk_mov_b32 v[180:181], v[176:177], v[176:177] op_sel:[0,1]
    v_pk_mov_b32 v[182:183], v[178:179], v[178:179] op_sel:[0,1]
    v_pk_mov_b32 v[184:185], v[176:177], v[176:177] op_sel:[0,1]
    v_pk_mov_b32 v[186:187], v[178:179], v[178:179] op_sel:[0,1]
    v_pk_mov_b32 v[188:189], v[176:177], v[176:177] op_sel:[0,1]
    v_pk_mov_b32 v[190:191], v[178:179], v[178:179] op_sel:[0,1]
    v_lshlrev_b32 v192, 16, v84
    v_and_b32 v193, 0xffff0000, v84
    v_lshlrev_b32 v194, 16, v85
    v_and_b32 v195, 0xffff0000, v85
    v_pk_mov_b32 v[196:197], v[192:193], v[192:193] op_sel:[0,1]
    v_pk_mov_b32 v[198:199], v[194:195], v[194:195] op_sel:[0,1]
    v_pk_mov_b32 v[200:201], v[192:193], v[192:193] op_sel:[0,1]
    v_pk_mov_b32 v[202:203], v[194:195], v[194:195] op_sel:[0,1]
    v_pk_mov_b32 v[204:205], v[192:193], v[192:193] op_sel:[0,1]
    v_pk_mov_b32 v[206:207], v[194:195], v[194:195] op_sel:[0,1]
    v_lshlrev_b32 v208, 16, v86
    v_and_b32 v209, 0xffff0000, v86
    v_lshlrev_b32 v210, 16, v87
    v_and_b32 v211, 0xffff0000, v87
    v_pk_mov_b32 v[212:213], v[208:209], v[208:209] op_sel:[0,1]
    v_pk_mov_b32 v[214:215], v[210:211], v[210:211] op_sel:[0,1]
    v_pk_mov_b32 v[216:217], v[208:209], v[208:209] op_sel:[0,1]
    v_pk_mov_b32 v[218:219], v[210:211], v[210:211] op_sel:[0,1]
    v_pk_mov_b32 v[220:221], v[208:209], v[208:209] op_sel:[0,1]
    v_pk_mov_b32 v[222:223], v[210:211], v[210:211] op_sel:[0,1]
    v_lshlrev_b32 v224, 16, v88
    v_and_b32 v225, 0xffff0000, v88
    v_lshlrev_b32 v226, 16, v89
    v_and_b32 v227, 0xffff0000, v89
    v_pk_mov_b32 v[228:229], v[224:225], v[224:225] op_sel:[0,1]
    v_pk_mov_b32 v[230:231], v[226:227], v[226:227] op_sel:[0,1]
    v_pk_mov_b32 v[232:233], v[224:225], v[224:225] op_sel:[0,1]
    v_pk_mov_b32 v[234:235], v[226:227], v[226:227] op_sel:[0,1]
    v_pk_mov_b32 v[236:237], v[224:225], v[224:225] op_sel:[0,1]
    v_pk_mov_b32 v[238:239], v[226:227], v[226:227] op_sel:[0,1]
    s_mov_b32 s36, s16
    s_and_b32 s37, s17, 0xffff
    s_mov_b32 s38, 256
    s_mov_b32 s39, 0x20000
    v_mov_b32 v18, 1
    v_mov_b32 v19, 0
    s_lshr_b32 s67, s62, 2
    s_barrier
    ds_read_b128 v[32:35], v4 offset:0
    ds_read_b128 v[36:39], v4 offset:2048
    ds_read_b128 v[40:43], v4 offset:4096
    ds_read_b128 v[44:47], v4 offset:6144
    ds_read_b64_tr_b16 v[48:49], v6 offset:256
    ds_read_b64_tr_b16 v[50:51], v6 offset:2304
    ds_read_b64_tr_b16 v[52:53], v7 offset:256
    ds_read_b64_tr_b16 v[54:55], v7 offset:2304
    ds_read_b64_tr_b16 v[56:57], v6 offset:768
    ds_read_b64_tr_b16 v[58:59], v6 offset:2816
    ds_read_b64_tr_b16 v[60:61], v7 offset:768
    ds_read_b64_tr_b16 v[62:63], v7 offset:2816
    ds_read_b64_tr_b16 v[64:65], v6 offset:1280
    ds_read_b64_tr_b16 v[66:67], v6 offset:3328
    ds_read_b64_tr_b16 v[68:69], v7 offset:1280
    ds_read_b64_tr_b16 v[70:71], v7 offset:3328
    ds_read_b64_tr_b16 v[72:73], v8 offset:0
    ds_read_b64_tr_b16 v[74:75], v8 offset:2048
    s_cmp_lg_u32 s3, 0
    s_cbranch_scc1 L_LOOP1
    s_mov_b64 exec, 1
    s_lshl_b32 s68, s20, 4
    buffer_atomic_add v18, v19, s[36:39], s68 offen sc1
    s_mov_b64 exec, -1
L_LOOP1:
    s_waitcnt lgkmcnt(0)
    v_mfma_f32_16x16x32_bf16 v[128:131], v[48:51], v[32:35], v[128:131]
    ds_read_b128 v[76:79], v5 offset:0
    v_mfma_f32_16x16x32_bf16 v[132:135], v[48:51], v[36:39], v[132:135]
    ds_read_b128 v[80:83], v5 offset:2048
    v_mfma_f32_16x16x32_bf16 v[136:139], v[48:51], v[40:43], v[136:139]
    ds_read_b128 v[84:87], v5 offset:4096
    v_mfma_f32_16x16x32_bf16 v[140:143], v[48:51], v[44:47], v[140:143]
    ds_read_b128 v[88:91], v5 offset:6144
    v_mfma_f32_16x16x32_bf16 v[144:147], v[52:55], v[32:35], v[144:147]
    ds_read_b64_tr_b16 v[92:93], v6 offset:16640
    v_mfma_f32_16x16x32_bf16 v[148:151], v[52:55], v[36:39], v[148:151]
    ds_read_b64_tr_b16 v[94:95], v6 offset:18688
    v_mfma_f32_16x16x32_bf16 v[152:155], v[52:55], v[40:43], v[152:155]
    ds_read_b64_tr_b16 v[96:97], v7 offset:16640
    v_mfma_f32_16x16x32_bf16 v[156:159], v[52:55], v[44:47], v[156:159]
    ds_read_b64_tr_b16 v[98:99], v7 offset:18688
    v_mfma_f32_16x16x32_bf16 v[160:163], v[56:59], v[32:35], v[160:163]
    ds_read_b64_tr_b16 v[100:101], v6 offset:17152
    v_mfma_f32_16x16x32_bf16 v[164:167], v[56:59], v[36:39], v[164:167]
    ds_read_b64_tr_b16 v[102:103], v6 offset:19200
    v_mfma_f32_16x16x32_bf16 v[168:171], v[56:59], v[40:43], v[168:171]
    ds_read_b64_tr_b16 v[104:105], v7 offset:17152
    v_mfma_f32_16x16x32_bf16 v[172:175], v[56:59], v[44:47], v[172:175]
    ds_read_b64_tr_b16 v[106:107], v7 offset:19200
    v_mfma_f32_16x16x32_bf16 v[176:179], v[60:63], v[32:35], v[176:179]
    ds_read_b64_tr_b16 v[108:109], v6 offset:17664
    v_mfma_f32_16x16x32_bf16 v[180:183], v[60:63], v[36:39], v[180:183]
    ds_read_b64_tr_b16 v[110:111], v6 offset:19712
    v_mfma_f32_16x16x32_bf16 v[184:187], v[60:63], v[40:43], v[184:187]
    ds_read_b64_tr_b16 v[112:113], v7 offset:17664
    v_mfma_f32_16x16x32_bf16 v[188:191], v[60:63], v[44:47], v[188:191]
    ds_read_b64_tr_b16 v[114:115], v7 offset:19712
    v_mfma_f32_16x16x32_bf16 v[192:195], v[64:67], v[32:35], v[192:195]
    ds_read_b64_tr_b16 v[116:117], v8 offset:16384
    v_mfma_f32_16x16x32_bf16 v[196:199], v[64:67], v[36:39], v[196:199]
    ds_read_b64_tr_b16 v[118:119], v8 offset:18432
    v_mfma_f32_16x16x32_bf16 v[200:203], v[64:67], v[40:43], v[200:203]
    s_add_u32 s64, s61, 49152
    v_mfma_f32_16x16x32_bf16 v[204:207], v[64:67], v[44:47], v[204:207]
    s_cmp_eq_u32 s64, 147456
    v_mfma_f32_16x16x32_bf16 v[208:211], v[68:71], v[32:35], v[208:211]
    s_cselect_b32 s64, 0, s64
    v_mfma_f32_16x16x32_bf16 v[212:215], v[68:71], v[36:39], v[212:215]
    s_sub_u32 s65, s64, s61
    v_mfma_f32_16x16x32_bf16 v[216:219], v[68:71], v[40:43], v[216:219]
    s_mov_b32 s61, s64
    v_mfma_f32_16x16x32_bf16 v[220:223], v[68:71], v[44:47], v[220:223]
    v_add_u32 v4, s65, v4
    v_mfma_f32_16x16x32_bf16 v[224:227], v[72:75], v[32:35], v[224:227]
    v_add_u32 v6, s65, v6
    v_mfma_f32_16x16x32_bf16 v[228:231], v[72:75], v[36:39], v[228:231]
    v_add_u32 v7, s65, v7
    v_mfma_f32_16x16x32_bf16 v[232:235], v[72:75], v[40:43], v[232:235]
    v_add_u32 v8, s65, v8
    v_mfma_f32_16x16x32_bf16 v[236:239], v[72:75], v[44:47], v[236:239]
    v_add_u32 v5, s65, v5
    s_waitcnt lgkmcnt(0)
    s_barrier
    v_mfma_f32_16x16x32_bf16 v[128:131], v[92:95], v[76:79], v[128:131]
    ds_read_b128 v[32:35], v4 offset:0
    v_mfma_f32_16x16x32_bf16 v[132:135], v[92:95], v[80:83], v[132:135]
    ds_read_b128 v[36:39], v4 offset:2048
    v_mfma_f32_16x16x32_bf16 v[136:139], v[92:95], v[84:87], v[136:139]
    ds_read_b128 v[40:43], v4 offset:4096
    v_mfma_f32_16x16x32_bf16 v[140:143], v[92:95], v[88:91], v[140:143]
    ds_read_b128 v[44:47], v4 offset:6144
    v_mfma_f32_16x16x32_bf16 v[144:147], v[96:99], v[76:79], v[144:147]
    ds_read_b64_tr_b16 v[48:49], v6 offset:256
    v_mfma_f32_16x16x32_bf16 v[148:151], v[96:99], v[80:83], v[148:151]
    ds_read_b64_tr_b16 v[50:51], v6 offset:2304
    v_mfma_f32_16x16x32_bf16 v[152:155], v[96:99], v[84:87], v[152:155]
    ds_read_b64_tr_b16 v[52:53], v7 offset:256
    v_mfma_f32_16x16x32_bf16 v[156:159], v[96:99], v[88:91], v[156:159]
    ds_read_b64_tr_b16 v[54:55], v7 offset:2304
    v_mfma_f32_16x16x32_bf16 v[160:163], v[100:103], v[76:79], v[160:163]
    ds_read_b64_tr_b16 v[56:57], v6 offset:768
    v_mfma_f32_16x16x32_bf16 v[164:167], v[100:103], v[80:83], v[164:167]
    ds_read_b64_tr_b16 v[58:59], v6 offset:2816
    v_mfma_f32_16x16x32_bf16 v[168:171], v[100:103], v[84:87], v[168:171]
    ds_read_b64_tr_b16 v[60:61], v7 offset:768
    v_mfma_f32_16x16x32_bf16 v[172:175], v[100:103], v[88:91], v[172:175]
    ds_read_b64_tr_b16 v[62:63], v7 offset:2816
    v_mfma_f32_16x16x32_bf16 v[176:179], v[104:107], v[76:79], v[176:179]
    ds_read_b64_tr_b16 v[64:65], v6 offset:1280
    v_mfma_f32_16x16x32_bf16 v[180:183], v[104:107], v[80:83], v[180:183]
    ds_read_b64_tr_b16 v[66:67], v6 offset:3328
    v_mfma_f32_16x16x32_bf16 v[184:187], v[104:107], v[84:87], v[184:187]
    ds_read_b64_tr_b16 v[68:69], v7 offset:1280
    v_mfma_f32_16x16x32_bf16 v[188:191], v[104:107], v[88:91], v[188:191]
    ds_read_b64_tr_b16 v[70:71], v7 offset:3328
    v_mfma_f32_16x16x32_bf16 v[192:195], v[108:111], v[76:79], v[192:195]
    ds_read_b64_tr_b16 v[72:73], v8 offset:0
    v_mfma_f32_16x16x32_bf16 v[196:199], v[108:111], v[80:83], v[196:199]
    ds_read_b64_tr_b16 v[74:75], v8 offset:2048
    v_mfma_f32_16x16x32_bf16 v[200:203], v[108:111], v[84:87], v[200:203]
    s_add_u32 s60, s60, 1
    v_mfma_f32_16x16x32_bf16 v[204:207], v[108:111], v[88:91], v[204:207]
    s_cmp_lt_u32 s60, 16
    v_mfma_f32_16x16x32_bf16 v[208:211], v[112:115], v[76:79], v[208:211]
    v_mfma_f32_16x16x32_bf16 v[212:215], v[112:115], v[80:83], v[212:215]
    v_mfma_f32_16x16x32_bf16 v[216:219], v[112:115], v[84:87], v[216:219]
    v_mfma_f32_16x16x32_bf16 v[220:223], v[112:115], v[88:91], v[220:223]
    v_mfma_f32_16x16x32_bf16 v[224:227], v[116:119], v[76:79], v[224:227]
    v_mfma_f32_16x16x32_bf16 v[228:231], v[116:119], v[80:83], v[228:231]
    v_mfma_f32_16x16x32_bf16 v[232:235], v[116:119], v[84:87], v[232:235]
    v_mfma_f32_16x16x32_bf16 v[236:239], v[116:119], v[88:91], v[236:239]
    s_waitcnt lgkmcnt(0)
    v_mfma_f32_16x16x32_bf16 v[128:131], v[48:51], v[32:35], v[128:131]
    ds_read_b128 v[76:79], v5 offset:0
    v_mfma_f32_16x16x32_bf16 v[132:135], v[48:51], v[36:39], v[132:135]
    ds_read_b128 v[80:83], v5 offset:2048
    v_mfma_f32_16x16x32_bf16 v[136:139], v[48:51], v[40:43], v[136:139]
    ds_read_b128 v[84:87], v5 offset:4096
    v_mfma_f32_16x16x32_bf16 v[140:143], v[48:51], v[44:47], v[140:143]
    ds_read_b128 v[88:91], v5 offset:6144
    v_mfma_f32_16x16x32_bf16 v[144:147], v[52:55], v[32:35], v[144:147]
    ds_read_b64_tr_b16 v[92:93], v6 offset:16640
    v_mfma_f32_16x16x32_bf16 v[148:151], v[52:55], v[36:39], v[148:151]
    ds_read_b64_tr_b16 v[94:95], v6 offset:18688
    v_mfma_f32_16x16x32_bf16 v[152:155], v[52:55], v[40:43], v[152:155]
    ds_read_b64_tr_b16 v[96:97], v7 offset:16640
    v_mfma_f32_16x16x32_bf16 v[156:159], v[52:55], v[44:47], v[156:159]
    ds_read_b64_tr_b16 v[98:99], v7 offset:18688
    v_mfma_f32_16x16x32_bf16 v[160:163], v[56:59], v[32:35], v[160:163]
    ds_read_b64_tr_b16 v[100:101], v6 offset:17152
    v_mfma_f32_16x16x32_bf16 v[164:167], v[56:59], v[36:39], v[164:167]
    ds_read_b64_tr_b16 v[102:103], v6 offset:19200
    v_mfma_f32_16x16x32_bf16 v[168:171], v[56:59], v[40:43], v[168:171]
    ds_read_b64_tr_b16 v[104:105], v7 offset:17152
    v_mfma_f32_16x16x32_bf16 v[172:175], v[56:59], v[44:47], v[172:175]
    ds_read_b64_tr_b16 v[106:107], v7 offset:19200
    v_mfma_f32_16x16x32_bf16 v[176:179], v[60:63], v[32:35], v[176:179]
    ds_read_b64_tr_b16 v[108:109], v6 offset:17664
    v_mfma_f32_16x16x32_bf16 v[180:183], v[60:63], v[36:39], v[180:183]
    ds_read_b64_tr_b16 v[110:111], v6 offset:19712
    v_mfma_f32_16x16x32_bf16 v[184:187], v[60:63], v[40:43], v[184:187]
    ds_read_b64_tr_b16 v[112:113], v7 offset:17664
    v_mfma_f32_16x16x32_bf16 v[188:191], v[60:63], v[44:47], v[188:191]
    ds_read_b64_tr_b16 v[114:115], v7 offset:19712
    v_mfma_f32_16x16x32_bf16 v[192:195], v[64:67], v[32:35], v[192:195]
    ds_read_b64_tr_b16 v[116:117], v8 offset:16384
    v_mfma_f32_16x16x32_bf16 v[196:199], v[64:67], v[36:39], v[196:199]
    ds_read_b64_tr_b16 v[118:119], v8 offset:18432
    v_mfma_f32_16x16x32_bf16 v[200:203], v[64:67], v[40:43], v[200:203]
    s_add_u32 s64, s61, 49152
    v_mfma_f32_16x16x32_bf16 v[204:207], v[64:67], v[44:47], v[204:207]
    s_cmp_eq_u32 s64, 147456
    v_mfma_f32_16x16x32_bf16 v[208:211], v[68:71], v[32:35], v[208:211]
    s_cselect_b32 s64, 0, s64
    v_mfma_f32_16x16x32_bf16 v[212:215], v[68:71], v[36:39], v[212:215]
    s_sub_u32 s65, s64, s61
    v_mfma_f32_16x16x32_bf16 v[216:219], v[68:71], v[40:43], v[216:219]
    s_mov_b32 s61, s64
    v_mfma_f32_16x16x32_bf16 v[220:223], v[68:71], v[44:47], v[220:223]
    v_add_u32 v4, s65, v4
    v_mfma_f32_16x16x32_bf16 v[224:227], v[72:75], v[32:35], v[224:227]
    v_add_u32 v6, s65, v6
    v_mfma_f32_16x16x32_bf16 v[228:231], v[72:75], v[36:39], v[228:231]
    v_add_u32 v7, s65, v7
    v_mfma_f32_16x16x32_bf16 v[232:235], v[72:75], v[40:43], v[232:235]
    v_add_u32 v8, s65, v8
    v_mfma_f32_16x16x32_bf16 v[236:239], v[72:75], v[44:47], v[236:239]
    v_add_u32 v5, s65, v5
    s_waitcnt lgkmcnt(0)
    s_barrier
    v_mfma_f32_16x16x32_bf16 v[128:131], v[92:95], v[76:79], v[128:131]
    ds_read_b128 v[32:35], v4 offset:0
    v_mfma_f32_16x16x32_bf16 v[132:135], v[92:95], v[80:83], v[132:135]
    ds_read_b128 v[36:39], v4 offset:2048
    v_mfma_f32_16x16x32_bf16 v[136:139], v[92:95], v[84:87], v[136:139]
    ds_read_b128 v[40:43], v4 offset:4096
    v_mfma_f32_16x16x32_bf16 v[140:143], v[92:95], v[88:91], v[140:143]
    ds_read_b128 v[44:47], v4 offset:6144
    v_mfma_f32_16x16x32_bf16 v[144:147], v[96:99], v[76:79], v[144:147]
    ds_read_b64_tr_b16 v[48:49], v6 offset:256
    v_mfma_f32_16x16x32_bf16 v[148:151], v[96:99], v[80:83], v[148:151]
    ds_read_b64_tr_b16 v[50:51], v6 offset:2304
    v_mfma_f32_16x16x32_bf16 v[152:155], v[96:99], v[84:87], v[152:155]
    ds_read_b64_tr_b16 v[52:53], v7 offset:256
    v_mfma_f32_16x16x32_bf16 v[156:159], v[96:99], v[88:91], v[156:159]
    ds_read_b64_tr_b16 v[54:55], v7 offset:2304
    v_mfma_f32_16x16x32_bf16 v[160:163], v[100:103], v[76:79], v[160:163]
    ds_read_b64_tr_b16 v[56:57], v6 offset:768
    v_mfma_f32_16x16x32_bf16 v[164:167], v[100:103], v[80:83], v[164:167]
    ds_read_b64_tr_b16 v[58:59], v6 offset:2816
    v_mfma_f32_16x16x32_bf16 v[168:171], v[100:103], v[84:87], v[168:171]
    ds_read_b64_tr_b16 v[60:61], v7 offset:768
    v_mfma_f32_16x16x32_bf16 v[172:175], v[100:103], v[88:91], v[172:175]
    ds_read_b64_tr_b16 v[62:63], v7 offset:2816
    v_mfma_f32_16x16x32_bf16 v[176:179], v[104:107], v[76:79], v[176:179]
    ds_read_b64_tr_b16 v[64:65], v6 offset:1280
    v_mfma_f32_16x16x32_bf16 v[180:183], v[104:107], v[80:83], v[180:183]
    ds_read_b64_tr_b16 v[66:67], v6 offset:3328
    v_mfma_f32_16x16x32_bf16 v[184:187], v[104:107], v[84:87], v[184:187]
    ds_read_b64_tr_b16 v[68:69], v7 offset:1280
    v_mfma_f32_16x16x32_bf16 v[188:191], v[104:107], v[88:91], v[188:191]
    ds_read_b64_tr_b16 v[70:71], v7 offset:3328
    v_mfma_f32_16x16x32_bf16 v[192:195], v[108:111], v[76:79], v[192:195]
    ds_read_b64_tr_b16 v[72:73], v8 offset:0
    v_mfma_f32_16x16x32_bf16 v[196:199], v[108:111], v[80:83], v[196:199]
    ds_read_b64_tr_b16 v[74:75], v8 offset:2048
    v_mfma_f32_16x16x32_bf16 v[200:203], v[108:111], v[84:87], v[200:203]
    s_add_u32 s60, s60, 1
    v_mfma_f32_16x16x32_bf16 v[204:207], v[108:111], v[88:91], v[204:207]
    s_cmp_lt_u32 s60, 16
    v_mfma_f32_16x16x32_bf16 v[208:211], v[112:115], v[76:79], v[208:211]
    v_mfma_f32_16x16x32_bf16 v[212:215], v[112:115], v[80:83], v[212:215]
    v_mfma_f32_16x16x32_bf16 v[216:219], v[112:115], v[84:87], v[216:219]
    v_mfma_f32_16x16x32_bf16 v[220:223], v[112:115], v[88:91], v[220:223]
    v_mfma_f32_16x16x32_bf16 v[224:227], v[116:119], v[76:79], v[224:227]
    v_mfma_f32_16x16x32_bf16 v[228:231], v[116:119], v[80:83], v[228:231]
    v_mfma_f32_16x16x32_bf16 v[232:235], v[116:119], v[84:87], v[232:235]
    v_mfma_f32_16x16x32_bf16 v[236:239], v[116:119], v[88:91], v[236:239]
    s_cbranch_scc1 L_LOOP1
    s_mov_b32 s46, 0xbdd2d3e8
    s_mov_b32 s47, 0xc0135761
    s_mul_i32 s48, s20, 112
    s_mul_i32 s49, s21, 7
    s_add_u32 s48, s48, s49
    s_lshl_b32 s66, s48, 13
    s_lshl_b32 s49, s40, 12
    s_add_u32 s48, s66, s49
    v_lshlrev_b32 v14, 4, v2
    v_and_b32 v15, 32, v2
    v_lshl_add_u32 v15, v15, 4, v14
    s_lshl_b32 s49, s41, 9
    v_add_u32 v15, s49, v15
    s_mov_b32 s50, s48
    s_lshl_b32 s49, s41, 13
    s_add_u32 s51, s48, s49
    s_add_u32 s51, s51, 8192
    s_add_u32 s52, s51, 16384
    s_add_u32 s53, s51, 32768
    s_mov_b32 s28, s12
    s_and_b32 s29, s13, 0xffff
    s_mov_b32 s30, 2048
    s_mov_b32 s31, 0x20000
    s_lshr_b32 s54, s21, 3
    s_lshl_b32 s54, s54, 7
    s_and_b32 s55, s21, 7
    s_lshl_b32 s55, s55, 8
    s_add_u32 s54, s54, s55
    v_lshrrev_b32 v16, 5, v2
    v_lshlrev_b32 v16, 3, v16
    s_waitcnt lgkmcnt(0)
    buffer_load_dwordx2 v[96:97], v16, s[28:31], s54 offen offset:0
    buffer_load_dwordx2 v[98:99], v16, s[28:31], s54 offen offset:16
    buffer_load_dwordx2 v[100:101], v16, s[28:31], s54 offen offset:32
    buffer_load_dwordx2 v[102:103], v16, s[28:31], s54 offen offset:48
    buffer_load_dwordx2 v[104:105], v16, s[28:31], s54 offen offset:64
    buffer_load_dwordx2 v[106:107], v16, s[28:31], s54 offen offset:80
    buffer_load_dwordx2 v[108:109], v16, s[28:31], s54 offen offset:96
    buffer_load_dwordx2 v[110:111], v16, s[28:31], s54 offen offset:112
    s_lshl_b32 s49, s40, 12
    s_add_u32 s49, s49, 98304
    v_add_u32 v21, s49, v15
    s_lshl_b32 s55, s41, 13
    s_add_u32 s49, s49, s55
    v_add_u32 v20, s49, v14
    v_pk_mul_f32 v[32:33], v[224:225], v[224:225]
    v_pk_mul_f32 v[34:35], v[226:227], v[226:227]
    v_pk_fma_f32 v[32:33], v[32:33], s[46:47], s[46:47] op_sel:[0,0,1] op_sel_hi:[1,0,1]
    v_pk_fma_f32 v[34:35], v[34:35], s[46:47], s[46:47] op_sel:[0,0,1] op_sel_hi:[1,0,1]
    v_pk_mul_f32 v[32:33], v[32:33], v[224:225]
    v_pk_mul_f32 v[34:35], v[34:35], v[226:227]
    v_exp_f32 v32, v32
    v_exp_f32 v33, v33
    v_exp_f32 v34, v34
    v_exp_f32 v35, v35
    v_pk_add_f32 v[32:33], v[32:33], 1.0 op_sel_hi:[1,0]
    v_pk_add_f32 v[34:35], v[34:35], 1.0 op_sel_hi:[1,0]
    v_rcp_f32 v32, v32
    v_rcp_f32 v33, v33
    v_rcp_f32 v34, v34
    v_rcp_f32 v35, v35
    v_pk_mul_f32 v[32:33], v[32:33], v[224:225]
    v_pk_mul_f32 v[34:35], v[34:35], v[226:227]
    v_cvt_pk_bf16_f32 v64, v32, v33
    v_cvt_pk_bf16_f32 v65, v34, v35
    v_pk_mul_f32 v[36:37], v[228:229], v[228:229]
    v_pk_mul_f32 v[38:39], v[230:231], v[230:231]
    v_pk_fma_f32 v[36:37], v[36:37], s[46:47], s[46:47] op_sel:[0,0,1] op_sel_hi:[1,0,1]
    v_pk_fma_f32 v[38:39], v[38:39], s[46:47], s[46:47] op_sel:[0,0,1] op_sel_hi:[1,0,1]
    v_pk_mul_f32 v[36:37], v[36:37], v[228:229]
    v_pk_mul_f32 v[38:39], v[38:39], v[230:231]
    v_exp_f32 v36, v36
    v_exp_f32 v37, v37
    v_exp_f32 v38, v38
    v_exp_f32 v39, v39
    v_pk_add_f32 v[36:37], v[36:37], 1.0 op_sel_hi:[1,0]
    v_pk_add_f32 v[38:39], v[38:39], 1.0 op_sel_hi:[1,0]
    v_rcp_f32 v36, v36
    v_rcp_f32 v37, v37
    v_rcp_f32 v38, v38
    v_rcp_f32 v39, v39
    v_pk_mul_f32 v[36:37], v[36:37], v[228:229]
    v_pk_mul_f32 v[38:39], v[38:39], v[230:231]
    v_cvt_pk_bf16_f32 v66, v36, v37
    v_cvt_pk_bf16_f32 v67, v38, v39
    s_nop 1
    v_permlane32_swap_b32 v64, v66
    v_permlane32_swap_b32 v65, v67
    buffer_store_dwordx4 v[64:67], v15, s[32:35], s50 offen offset:0 sc1
    ds_write_b128 v21, v[64:67] offset:0
    v_pk_mul_f32 v[32:33], v[232:233], v[232:233]
    v_pk_mul_f32 v[34:35], v[234:235], v[234:235]
    v_pk_fma_f32 v[32:33], v[32:33], s[46:47], s[46:47] op_sel:[0,0,1] op_sel_hi:[1,0,1]
    v_pk_fma_f32 v[34:35], v[34:35], s[46:47], s[46:47] op_sel:[0,0,1] op_sel_hi:[1,0,1]
    v_pk_mul_f32 v[32:33], v[32:33], v[232:233]
    v_pk_mul_f32 v[34:35], v[34:35], v[234:235]
    v_exp_f32 v32, v32
    v_exp_f32 v33, v33
    v_exp_f32 v34, v34
    v_exp_f32 v35, v35
    v_pk_add_f32 v[32:33], v[32:33], 1.0 op_sel_hi:[1,0]
    v_pk_add_f32 v[34:35], v[34:35], 1.0 op_sel_hi:[1,0]
    v_rcp_f32 v32, v32
    v_rcp_f32 v33, v33
    v_rcp_f32 v34, v34
    v_rcp_f32 v35, v35
    v_pk_mul_f32 v[32:33], v[32:33], v[232:233]
    v_pk_mul_f32 v[34:35], v[34:35], v[234:235]
    v_cvt_pk_bf16_f32 v68, v32, v33
    v_cvt_pk_bf16_f32 v69, v34, v35
    v_pk_mul_f32 v[36:37], v[236:237], v[236:237]
    v_pk_mul_f32 v[38:39], v[238:239], v[238:239]
    v_pk_fma_f32 v[36:37], v[36:37], s[46:47], s[46:47] op_sel:[0,0,1] op_sel_hi:[1,0,1]
    v_pk_fma_f32 v[38:39], v[38:39], s[46:47], s[46:47] op_sel:[0,0,1] op_sel_hi:[1,0,1]
    v_pk_mul_f32 v[36:37], v[36:37], v[236:237]
    v_pk_mul_f32 v[38:39], v[38:39], v[238:239]
    v_exp_f32 v36, v36
    v_exp_f32 v37, v37
    v_exp_f32 v38, v38
    v_exp_f32 v39, v39
    v_pk_add_f32 v[36:37], v[36:37], 1.0 op_sel_hi:[1,0]
    v_pk_add_f32 v[38:39], v[38:39], 1.0 op_sel_hi:[1,0]
    v_rcp_f32 v36, v36
    v_rcp_f32 v37, v37
    v_rcp_f32 v38, v38
    v_rcp_f32 v39, v39
    v_pk_mul_f32 v[36:37], v[36:37], v[236:237]
    v_pk_mul_f32 v[38:39], v[38:39], v[238:239]
    v_cvt_pk_bf16_f32 v70, v36, v37
    v_cvt_pk_bf16_f32 v71, v38, v39
    s_nop 1
    v_permlane32_swap_b32 v68, v70
    v_permlane32_swap_b32 v69, v71
    buffer_store_dwordx4 v[68:71], v15, s[32:35], s50 offen offset:2048 sc1
    ds_write_b128 v21, v[68:71] offset:2048
    v_pk_mul_f32 v[32:33], v[128:129], v[128:129]
    v_pk_mul_f32 v[34:35], v[130:131], v[130:131]
    v_pk_fma_f32 v[32:33], v[32:33], s[46:47], s[46:47] op_sel:[0,0,1] op_sel_hi:[1,0,1]
    v_pk_fma_f32 v[34:35], v[34:35], s[46:47], s[46:47] op_sel:[0,0,1] op_sel_hi:[1,0,1]
    v_pk_mul_f32 v[32:33], v[32:33], v[128:129]
    v_pk_mul_f32 v[34:35], v[34:35], v[130:131]
    v_exp_f32 v32, v32
    v_exp_f32 v33, v33
    v_exp_f32 v34, v34
    v_exp_f32 v35, v35
    v_pk_add_f32 v[32:33], v[32:33], 1.0 op_sel_hi:[1,0]
    v_pk_add_f32 v[34:35], v[34:35], 1.0 op_sel_hi:[1,0]
    v_rcp_f32 v32, v32
    v_rcp_f32 v33, v33
    v_rcp_f32 v34, v34
    v_rcp_f32 v35, v35
    v_pk_mul_f32 v[32:33], v[32:33], v[128:129]
    v_pk_mul_f32 v[34:35], v[34:35], v[130:131]
    v_cvt_pk_bf16_f32 v72, v32, v33
    v_cvt_pk_bf16_f32 v73, v34, v35
    v_pk_mul_f32 v[36:37], v[144:145], v[144:145]
    v_pk_mul_f32 v[38:39], v[146:147], v[146:147]
    v_pk_fma_f32 v[36:37], v[36:37], s[46:47], s[46:47] op_sel:[0,0,1] op_sel_hi:[1,0,1]
    v_pk_fma_f32 v[38:39], v[38:39], s[46:47], s[46:47] op_sel:[0,0,1] op_sel_hi:[1,0,1]
    v_pk_mul_f32 v[36:37], v[36:37], v[144:145]
    v_pk_mul_f32 v[38:39], v[38:39], v[146:147]
    v_exp_f32 v36, v36
    v_exp_f32 v37, v37
    v_exp_f32 v38, v38
    v_exp_f32 v39, v39
    v_pk_add_f32 v[36:37], v[36:37], 1.0 op_sel_hi:[1,0]
    v_pk_add_f32 v[38:39], v[38:39], 1.0 op_sel_hi:[1,0]
    v_rcp_f32 v36, v36
    v_rcp_f32 v37, v37
    v_rcp_f32 v38, v38
    v_rcp_f32 v39, v39
    v_pk_mul_f32 v[36:37], v[36:37], v[144:145]
    v_pk_mul_f32 v[38:39], v[38:39], v[146:147]
    v_cvt_pk_bf16_f32 v74, v36, v37
    v_cvt_pk_bf16_f32 v75, v38, v39
    buffer_store_dwordx4 v[72:75], v14, s[32:35], s51 offen offset:0 sc1
    ds_write_b128 v20, v[72:75] offset:8192
    v_pk_mul_f32 v[32:33], v[132:133], v[132:133]
    v_pk_mul_f32 v[34:35], v[134:135], v[134:135]
    v_pk_fma_f32 v[32:33], v[32:33], s[46:47], s[46:47] op_sel:[0,0,1] op_sel_hi:[1,0,1]
    v_pk_fma_f32 v[34:35], v[34:35], s[46:47], s[46:47] op_sel:[0,0,1] op_sel_hi:[1,0,1]
    v_pk_mul_f32 v[32:33], v[32:33], v[132:133]
    v_pk_mul_f32 v[34:35], v[34:35], v[134:135]
    v_exp_f32 v32, v32
    v_exp_f32 v33, v33
    v_exp_f32 v34, v34
    v_exp_f32 v35, v35
    v_pk_add_f32 v[32:33], v[32:33], 1.0 op_sel_hi:[1,0]
    v_pk_add_f32 v[34:35], v[34:35], 1.0 op_sel_hi:[1,0]
    v_rcp_f32 v32, v32
    v_rcp_f32 v33, v33
    v_rcp_f32 v34, v34
    v_rcp_f32 v35, v35
    v_pk_mul_f32 v[32:33], v[32:33], v[132:133]
    v_pk_mul_f32 v[34:35], v[34:35], v[134:135]
    v_cvt_pk_bf16_f32 v76, v32, v33
    v_cvt_pk_bf16_f32 v77, v34, v35
    v_pk_mul_f32 v[36:37], v[148:149], v[148:149]
    v_pk_mul_f32 v[38:39], v[150:151], v[150:151]
    v_pk_fma_f32 v[36:37], v[36:37], s[46:47], s[46:47] op_sel:[0,0,1] op_sel_hi:[1,0,1]
    v_pk_fma_f32 v[38:39], v[38:39], s[46:47], s[46:47] op_sel:[0,0,1] op_sel_hi:[1,0,1]
    v_pk_mul_f32 v[36:37], v[36:37], v[148:149]
    v_pk_mul_f32 v[38:39], v[38:39], v[150:151]
    v_exp_f32 v36, v36
    v_exp_f32 v37, v37
    v_exp_f32 v38, v38
    v_exp_f32 v39, v39
    v_pk_add_f32 v[36:37], v[36:37], 1.0 op_sel_hi:[1,0]
    v_pk_add_f32 v[38:39], v[38:39], 1.0 op_sel_hi:[1,0]
    v_rcp_f32 v36, v36
    v_rcp_f32 v37, v37
    v_rcp_f32 v38, v38
    v_rcp_f32 v39, v39
    v_pk_mul_f32 v[36:37], v[36:37], v[148:149]
    v_pk_mul_f32 v[38:39], v[38:39], v[150:151]
    v_cvt_pk_bf16_f32 v78, v36, v37
    v_cvt_pk_bf16_f32 v79, v38, v39
    buffer_store_dwordx4 v[76:79], v14, s[32:35], s51 offen offset:1024 sc1
    ds_write_b128 v20, v[76:79] offset:9216
    v_pk_mul_f32 v[32:33], v[136:137], v[136:137]
    v_pk_mul_f32 v[34:35], v[138:139], v[138:139]
    v_pk_fma_f32 v[32:33], v[32:33], s[46:47], s[46:47] op_sel:[0,0,1] op_sel_hi:[1,0,1]
    v_pk_fma_f32 v[34:35], v[34:35], s[46:47], s[46:47] op_sel:[0,0,1] op_sel_hi:[1,0,1]
    v_pk_mul_f32 v[32:33], v[32:33], v[136:137]
    v_pk_mul_f32 v[34:35], v[34:35], v[138:139]
    v_exp_f32 v32, v32
    v_exp_f32 v33, v33
    v_exp_f32 v34, v34
    v_exp_f32 v35, v35
    v_pk_add_f32 v[32:33], v[32:33], 1.0 op_sel_hi:[1,0]
    v_pk_add_f32 v[34:35], v[34:35], 1.0 op_sel_hi:[1,0]
    v_rcp_f32 v32, v32
    v_rcp_f32 v33, v33
    v_rcp_f32 v34, v34
    v_rcp_f32 v35, v35
    v_pk_mul_f32 v[32:33], v[32:33], v[136:137]
    v_pk_mul_f32 v[34:35], v[34:35], v[138:139]
    v_cvt_pk_bf16_f32 v80, v32, v33
    v_cvt_pk_bf16_f32 v81, v34, v35
    v_pk_mul_f32 v[36:37], v[152:153], v[152:153]
    v_pk_mul_f32 v[38:39], v[154:155], v[154:155]
    v_pk_fma_f32 v[36:37], v[36:37], s[46:47], s[46:47] op_sel:[0,0,1] op_sel_hi:[1,0,1]
    v_pk_fma_f32 v[38:39], v[38:39], s[46:47], s[46:47] op_sel:[0,0,1] op_sel_hi:[1,0,1]
    v_pk_mul_f32 v[36:37], v[36:37], v[152:153]
    v_pk_mul_f32 v[38:39], v[38:39], v[154:155]
    v_exp_f32 v36, v36
    v_exp_f32 v37, v37
    v_exp_f32 v38, v38
    v_exp_f32 v39, v39
    v_pk_add_f32 v[36:37], v[36:37], 1.0 op_sel_hi:[1,0]
    v_pk_add_f32 v[38:39], v[38:39], 1.0 op_sel_hi:[1,0]
    v_rcp_f32 v36, v36
    v_rcp_f32 v37, v37
    v_rcp_f32 v38, v38
    v_rcp_f32 v39, v39
    v_pk_mul_f32 v[36:37], v[36:37], v[152:153]
    v_pk_mul_f32 v[38:39], v[38:39], v[154:155]
    v_cvt_pk_bf16_f32 v82, v36, v37
    v_cvt_pk_bf16_f32 v83, v38, v39
    buffer_store_dwordx4 v[80:83], v14, s[32:35], s51 offen offset:2048 sc1
    ds_write_b128 v20, v[80:83] offset:10240
    v_pk_mul_f32 v[32:33], v[140:141], v[140:141]
    v_pk_mul_f32 v[34:35], v[142:143], v[142:143]
    v_pk_fma_f32 v[32:33], v[32:33], s[46:47], s[46:47] op_sel:[0,0,1] op_sel_hi:[1,0,1]
    v_pk_fma_f32 v[34:35], v[34:35], s[46:47], s[46:47] op_sel:[0,0,1] op_sel_hi:[1,0,1]
    v_pk_mul_f32 v[32:33], v[32:33], v[140:141]
    v_pk_mul_f32 v[34:35], v[34:35], v[142:143]
    v_exp_f32 v32, v32
    v_exp_f32 v33, v33
    v_exp_f32 v34, v34
    v_exp_f32 v35, v35
    v_pk_add_f32 v[32:33], v[32:33], 1.0 op_sel_hi:[1,0]
    v_pk_add_f32 v[34:35], v[34:35], 1.0 op_sel_hi:[1,0]
    v_rcp_f32 v32, v32
    v_rcp_f32 v33, v33
    v_rcp_f32 v34, v34
    v_rcp_f32 v35, v35
    v_pk_mul_f32 v[32:33], v[32:33], v[140:141]
    v_pk_mul_f32 v[34:35], v[34:35], v[142:143]
    v_cvt_pk_bf16_f32 v84, v32, v33
    v_cvt_pk_bf16_f32 v85, v34, v35
    v_pk_mul_f32 v[36:37], v[156:157], v[156:157]
    v_pk_mul_f32 v[38:39], v[158:159], v[158:159]
    v_pk_fma_f32 v[36:37], v[36:37], s[46:47], s[46:47] op_sel:[0,0,1] op_sel_hi:[1,0,1]
    v_pk_fma_f32 v[38:39], v[38:39], s[46:47], s[46:47] op_sel:[0,0,1] op_sel_hi:[1,0,1]
    v_pk_mul_f32 v[36:37], v[36:37], v[156:157]
    v_pk_mul_f32 v[38:39], v[38:39], v[158:159]
    v_exp_f32 v36, v36
    v_exp_f32 v37, v37
    v_exp_f32 v38, v38
    v_exp_f32 v39, v39
    v_pk_add_f32 v[36:37], v[36:37], 1.0 op_sel_hi:[1,0]
    v_pk_add_f32 v[38:39], v[38:39], 1.0 op_sel_hi:[1,0]
    v_rcp_f32 v36, v36
    v_rcp_f32 v37, v37
    v_rcp_f32 v38, v38
    v_rcp_f32 v39, v39
    v_pk_mul_f32 v[36:37], v[36:37], v[156:157]
    v_pk_mul_f32 v[38:39], v[38:39], v[158:159]
    v_cvt_pk_bf16_f32 v86, v36, v37
    v_cvt_pk_bf16_f32 v87, v38, v39
    buffer_store_dwordx4 v[84:87], v14, s[32:35], s51 offen offset:3072 sc1
    ds_write_b128 v20, v[84:87] offset:11264
    v_pk_mul_f32 v[32:33], v[160:161], v[160:161]
    v_pk_mul_f32 v[34:35], v[162:163], v[162:163]
    v_pk_fma_f32 v[32:33], v[32:33], s[46:47], s[46:47] op_sel:[0,0,1] op_sel_hi:[1,0,1]
    v_pk_fma_f32 v[34:35], v[34:35], s[46:47], s[46:47] op_sel:[0,0,1] op_sel_hi:[1,0,1]
    v_pk_mul_f32 v[32:33], v[32:33], v[160:161]
    v_pk_mul_f32 v[34:35], v[34:35], v[162:163]
    v_exp_f32 v32, v32
    v_exp_f32 v33, v33
    v_exp_f32 v34, v34
    v_exp_f32 v35, v35
    v_pk_add_f32 v[32:33], v[32:33], 1.0 op_sel_hi:[1,0]
    v_pk_add_f32 v[34:35], v[34:35], 1.0 op_sel_hi:[1,0]
    v_rcp_f32 v32, v32
    v_rcp_f32 v33, v33
    v_rcp_f32 v34, v34
    v_rcp_f32 v35, v35
    v_pk_mul_f32 v[32:33], v[32:33], v[160:161]
    v_pk_mul_f32 v[34:35], v[34:35], v[162:163]
    v_cvt_pk_bf16_f32 v88, v32, v33
    v_cvt_pk_bf16_f32 v89, v34, v35
    v_pk_mul_f32 v[36:37], v[176:177], v[176:177]
    v_pk_mul_f32 v[38:39], v[178:179], v[178:179]
    v_pk_fma_f32 v[36:37], v[36:37], s[46:47], s[46:47] op_sel:[0,0,1] op_sel_hi:[1,0,1]
    v_pk_fma_f32 v[38:39], v[38:39], s[46:47], s[46:47] op_sel:[0,0,1] op_sel_hi:[1,0,1]
    v_pk_mul_f32 v[36:37], v[36:37], v[176:177]
    v_pk_mul_f32 v[38:39], v[38:39], v[178:179]
    v_exp_f32 v36, v36
    v_exp_f32 v37, v37
    v_exp_f32 v38, v38
    v_exp_f32 v39, v39
    v_pk_add_f32 v[36:37], v[36:37], 1.0 op_sel_hi:[1,0]
    v_pk_add_f32 v[38:39], v[38:39], 1.0 op_sel_hi:[1,0]
    v_rcp_f32 v36, v36
    v_rcp_f32 v37, v37
    v_rcp_f32 v38, v38
    v_rcp_f32 v39, v39
    v_pk_mul_f32 v[36:37], v[36:37], v[176:177]
    v_pk_mul_f32 v[38:39], v[38:39], v[178:179]
    v_cvt_pk_bf16_f32 v90, v36, v37
    v_cvt_pk_bf16_f32 v91, v38, v39
    buffer_store_dwordx4 v[88:91], v14, s[32:35], s52 offen offset:0 sc1
    ds_write_b128 v20, v[88:91] offset:24576
    v_pk_mul_f32 v[32:33], v[164:165], v[164:165]
    v_pk_mul_f32 v[34:35], v[166:167], v[166:167]
    v_pk_fma_f32 v[32:33], v[32:33], s[46:47], s[46:47] op_sel:[0,0,1] op_sel_hi:[1,0,1]
    v_pk_fma_f32 v[34:35], v[34:35], s[46:47], s[46:47] op_sel:[0,0,1] op_sel_hi:[1,0,1]
    v_pk_mul_f32 v[32:33], v[32:33], v[164:165]
    v_pk_mul_f32 v[34:35], v[34:35], v[166:167]
    v_exp_f32 v32, v32
    v_exp_f32 v33, v33
    v_exp_f32 v34, v34
    v_exp_f32 v35, v35
    v_pk_add_f32 v[32:33], v[32:33], 1.0 op_sel_hi:[1,0]
    v_pk_add_f32 v[34:35], v[34:35], 1.0 op_sel_hi:[1,0]
    v_rcp_f32 v32, v32
    v_rcp_f32 v33, v33
    v_rcp_f32 v34, v34
    v_rcp_f32 v35, v35
    v_pk_mul_f32 v[32:33], v[32:33], v[164:165]
    v_pk_mul_f32 v[34:35], v[34:35], v[166:167]
    v_cvt_pk_bf16_f32 v92, v32, v33
    v_cvt_pk_bf16_f32 v93, v34, v35
    v_pk_mul_f32 v[36:37], v[180:181], v[180:181]
    v_pk_mul_f32 v[38:39], v[182:183], v[182:183]
    v_pk_fma_f32 v[36:37], v[36:37], s[46:47], s[46:47] op_sel:[0,0,1] op_sel_hi:[1,0,1]
    v_pk_fma_f32 v[38:39], v[38:39], s[46:47], s[46:47] op_sel:[0,0,1] op_sel_hi:[1,0,1]
    v_pk_mul_f32 v[36:37], v[36:37], v[180:181]
    v_pk_mul_f32 v[38:39], v[38:39], v[182:183]
    v_exp_f32 v36, v36
    v_exp_f32 v37, v37
    v_exp_f32 v38, v38
    v_exp_f32 v39, v39
    v_pk_add_f32 v[36:37], v[36:37], 1.0 op_sel_hi:[1,0]
    v_pk_add_f32 v[38:39], v[38:39], 1.0 op_sel_hi:[1,0]
    v_rcp_f32 v36, v36
    v_rcp_f32 v37, v37
    v_rcp_f32 v38, v38
    v_rcp_f32 v39, v39
    v_pk_mul_f32 v[36:37], v[36:37], v[180:181]
    v_pk_mul_f32 v[38:39], v[38:39], v[182:183]
    v_cvt_pk_bf16_f32 v94, v36, v37
    v_cvt_pk_bf16_f32 v95, v38, v39
    buffer_store_dwordx4 v[92:95], v14, s[32:35], s52 offen offset:1024 sc1
    ds_write_b128 v20, v[92:95] offset:25600
    v_pk_mul_f32 v[32:33], v[168:169], v[168:169]
    v_pk_mul_f32 v[34:35], v[170:171], v[170:171]
    v_pk_fma_f32 v[32:33], v[32:33], s[46:47], s[46:47] op_sel:[0,0,1] op_sel_hi:[1,0,1]
    v_pk_fma_f32 v[34:35], v[34:35], s[46:47], s[46:47] op_sel:[0,0,1] op_sel_hi:[1,0,1]
    v_pk_mul_f32 v[32:33], v[32:33], v[168:169]
    v_pk_mul_f32 v[34:35], v[34:35], v[170:171]
    v_exp_f32 v32, v32
    v_exp_f32 v33, v33
    v_exp_f32 v34, v34
    v_exp_f32 v35, v35
    v_pk_add_f32 v[32:33], v[32:33], 1.0 op_sel_hi:[1,0]
    v_pk_add_f32 v[34:35], v[34:35], 1.0 op_sel_hi:[1,0]
    v_rcp_f32 v32, v32
    v_rcp_f32 v33, v33
    v_rcp_f32 v34, v34
    v_rcp_f32 v35, v35
    v_pk_mul_f32 v[32:33], v[32:33], v[168:169]
    v_pk_mul_f32 v[34:35], v[34:35], v[170:171]
    v_cvt_pk_bf16_f32 v64, v32, v33
    v_cvt_pk_bf16_f32 v65, v34, v35
    v_pk_mul_f32 v[36:37], v[184:185], v[184:185]
    v_pk_mul_f32 v[38:39], v[186:187], v[186:187]
    v_pk_fma_f32 v[36:37], v[36:37], s[46:47], s[46:47] op_sel:[0,0,1] op_sel_hi:[1,0,1]
    v_pk_fma_f32 v[38:39], v[38:39], s[46:47], s[46:47] op_sel:[0,0,1] op_sel_hi:[1,0,1]
    v_pk_mul_f32 v[36:37], v[36:37], v[184:185]
    v_pk_mul_f32 v[38:39], v[38:39], v[186:187]
    v_exp_f32 v36, v36
    v_exp_f32 v37, v37
    v_exp_f32 v38, v38
    v_exp_f32 v39, v39
    v_pk_add_f32 v[36:37], v[36:37], 1.0 op_sel_hi:[1,0]
    v_pk_add_f32 v[38:39], v[38:39], 1.0 op_sel_hi:[1,0]
    v_rcp_f32 v36, v36
    v_rcp_f32 v37, v37
    v_rcp_f32 v38, v38
    v_rcp_f32 v39, v39
    v_pk_mul_f32 v[36:37], v[36:37], v[184:185]
    v_pk_mul_f32 v[38:39], v[38:39], v[186:187]
    v_cvt_pk_bf16_f32 v66, v36, v37
    v_cvt_pk_bf16_f32 v67, v38, v39
    buffer_store_dwordx4 v[64:67], v14, s[32:35], s52 offen offset:2048 sc1
    ds_write_b128 v20, v[64:67] offset:26624
    v_pk_mul_f32 v[32:33], v[172:173], v[172:173]
    v_pk_mul_f32 v[34:35], v[174:175], v[174:175]
    v_pk_fma_f32 v[32:33], v[32:33], s[46:47], s[46:47] op_sel:[0,0,1] op_sel_hi:[1,0,1]
    v_pk_fma_f32 v[34:35], v[34:35], s[46:47], s[46:47] op_sel:[0,0,1] op_sel_hi:[1,0,1]
    v_pk_mul_f32 v[32:33], v[32:33], v[172:173]
    v_pk_mul_f32 v[34:35], v[34:35], v[174:175]
    v_exp_f32 v32, v32
    v_exp_f32 v33, v33
    v_exp_f32 v34, v34
    v_exp_f32 v35, v35
    v_pk_add_f32 v[32:33], v[32:33], 1.0 op_sel_hi:[1,0]
    v_pk_add_f32 v[34:35], v[34:35], 1.0 op_sel_hi:[1,0]
    v_rcp_f32 v32, v32
    v_rcp_f32 v33, v33
    v_rcp_f32 v34, v34
    v_rcp_f32 v35, v35
    v_pk_mul_f32 v[32:33], v[32:33], v[172:173]
    v_pk_mul_f32 v[34:35], v[34:35], v[174:175]
    v_cvt_pk_bf16_f32 v68, v32, v33
    v_cvt_pk_bf16_f32 v69, v34, v35
    v_pk_mul_f32 v[36:37], v[188:189], v[188:189]
    v_pk_mul_f32 v[38:39], v[190:191], v[190:191]
    v_pk_fma_f32 v[36:37], v[36:37], s[46:47], s[46:47] op_sel:[0,0,1] op_sel_hi:[1,0,1]
    v_pk_fma_f32 v[38:39], v[38:39], s[46:47], s[46:47] op_sel:[0,0,1] op_sel_hi:[1,0,1]
    v_pk_mul_f32 v[36:37], v[36:37], v[188:189]
    v_pk_mul_f32 v[38:39], v[38:39], v[190:191]
    v_exp_f32 v36, v36
    v_exp_f32 v37, v37
    v_exp_f32 v38, v38
    v_exp_f32 v39, v39
    v_pk_add_f32 v[36:37], v[36:37], 1.0 op_sel_hi:[1,0]
    v_pk_add_f32 v[38:39], v[38:39], 1.0 op_sel_hi:[1,0]
    v_rcp_f32 v36, v36
    v_rcp_f32 v37, v37
    v_rcp_f32 v38, v38
    v_rcp_f32 v39, v39
    v_pk_mul_f32 v[36:37], v[36:37], v[188:189]
    v_pk_mul_f32 v[38:39], v[38:39], v[190:191]
    v_cvt_pk_bf16_f32 v70, v36, v37
    v_cvt_pk_bf16_f32 v71, v38, v39
    buffer_store_dwordx4 v[68:71], v14, s[32:35], s52 offen offset:3072 sc1
    ds_write_b128 v20, v[68:71] offset:27648
    v_pk_mul_f32 v[32:33], v[192:193], v[192:193]
    v_pk_mul_f32 v[34:35], v[194:195], v[194:195]
    v_pk_fma_f32 v[32:33], v[32:33], s[46:47], s[46:47] op_sel:[0,0,1] op_sel_hi:[1,0,1]
    v_pk_fma_f32 v[34:35], v[34:35], s[46:47], s[46:47] op_sel:[0,0,1] op_sel_hi:[1,0,1]
    v_pk_mul_f32 v[32:33], v[32:33], v[192:193]
    v_pk_mul_f32 v[34:35], v[34:35], v[194:195]
    v_exp_f32 v32, v32
    v_exp_f32 v33, v33
    v_exp_f32 v34, v34
    v_exp_f32 v35, v35
    v_pk_add_f32 v[32:33], v[32:33], 1.0 op_sel_hi:[1,0]
    v_pk_add_f32 v[34:35], v[34:35], 1.0 op_sel_hi:[1,0]
    v_rcp_f32 v32, v32
    v_rcp_f32 v33, v33
    v_rcp_f32 v34, v34
    v_rcp_f32 v35, v35
    v_pk_mul_f32 v[32:33], v[32:33], v[192:193]
    v_pk_mul_f32 v[34:35], v[34:35], v[194:195]
    v_cvt_pk_bf16_f32 v72, v32, v33
    v_cvt_pk_bf16_f32 v73, v34, v35
    v_pk_mul_f32 v[36:37], v[208:209], v[208:209]
    v_pk_mul_f32 v[38:39], v[210:211], v[210:211]
    v_pk_fma_f32 v[36:37], v[36:37], s[46:47], s[46:47] op_sel:[0,0,1] op_sel_hi:[1,0,1]
    v_pk_fma_f32 v[38:39], v[38:39], s[46:47], s[46:47] op_sel:[0,0,1] op_sel_hi:[1,0,1]
    v_pk_mul_f32 v[36:37], v[36:37], v[208:209]
    v_pk_mul_f32 v[38:39], v[38:39], v[210:211]
    v_exp_f32 v36, v36
    v_exp_f32 v37, v37
    v_exp_f32 v38, v38
    v_exp_f32 v39, v39
    v_pk_add_f32 v[36:37], v[36:37], 1.0 op_sel_hi:[1,0]
    v_pk_add_f32 v[38:39], v[38:39], 1.0 op_sel_hi:[1,0]
    v_rcp_f32 v36, v36
    v_rcp_f32 v37, v37
    v_rcp_f32 v38, v38
    v_rcp_f32 v39, v39
    v_pk_mul_f32 v[36:37], v[36:37], v[208:209]
    v_pk_mul_f32 v[38:39], v[38:39], v[210:211]
    v_cvt_pk_bf16_f32 v74, v36, v37
    v_cvt_pk_bf16_f32 v75, v38, v39
    buffer_store_dwordx4 v[72:75], v14, s[32:35], s53 offen offset:0 sc1
    ds_write_b128 v20, v[72:75] offset:40960
    v_pk_mul_f32 v[32:33], v[196:197], v[196:197]
    v_pk_mul_f32 v[34:35], v[198:199], v[198:199]
    v_pk_fma_f32 v[32:33], v[32:33], s[46:47], s[46:47] op_sel:[0,0,1] op_sel_hi:[1,0,1]
    v_pk_fma_f32 v[34:35], v[34:35], s[46:47], s[46:47] op_sel:[0,0,1] op_sel_hi:[1,0,1]
    v_pk_mul_f32 v[32:33], v[32:33], v[196:197]
    v_pk_mul_f32 v[34:35], v[34:35], v[198:199]
    v_exp_f32 v32, v32
    v_exp_f32 v33, v33
    v_exp_f32 v34, v34
    v_exp_f32 v35, v35
    v_pk_add_f32 v[32:33], v[32:33], 1.0 op_sel_hi:[1,0]
    v_pk_add_f32 v[34:35], v[34:35], 1.0 op_sel_hi:[1,0]
    v_rcp_f32 v32, v32
    v_rcp_f32 v33, v33
    v_rcp_f32 v34, v34
    v_rcp_f32 v35, v35
    v_pk_mul_f32 v[32:33], v[32:33], v[196:197]
    v_pk_mul_f32 v[34:35], v[34:35], v[198:199]
    v_cvt_pk_bf16_f32 v76, v32, v33
    v_cvt_pk_bf16_f32 v77, v34, v35
    v_pk_mul_f32 v[36:37], v[212:213], v[212:213]
    v_pk_mul_f32 v[38:39], v[214:215], v[214:215]
    v_pk_fma_f32 v[36:37], v[36:37], s[46:47], s[46:47] op_sel:[0,0,1] op_sel_hi:[1,0,1]
    v_pk_fma_f32 v[38:39], v[38:39], s[46:47], s[46:47] op_sel:[0,0,1] op_sel_hi:[1,0,1]
    v_pk_mul_f32 v[36:37], v[36:37], v[212:213]
    v_pk_mul_f32 v[38:39], v[38:39], v[214:215]
    v_exp_f32 v36, v36
    v_exp_f32 v37, v37
    v_exp_f32 v38, v38
    v_exp_f32 v39, v39
    v_pk_add_f32 v[36:37], v[36:37], 1.0 op_sel_hi:[1,0]
    v_pk_add_f32 v[38:39], v[38:39], 1.0 op_sel_hi:[1,0]
    v_rcp_f32 v36, v36
    v_rcp_f32 v37, v37
    v_rcp_f32 v38, v38
    v_rcp_f32 v39, v39
    v_pk_mul_f32 v[36:37], v[36:37], v[212:213]
    v_pk_mul_f32 v[38:39], v[38:39], v[214:215]
    v_cvt_pk_bf16_f32 v78, v36, v37
    v_cvt_pk_bf16_f32 v79, v38, v39
    buffer_store_dwordx4 v[76:79], v14, s[32:35], s53 offen offset:1024 sc1
    ds_write_b128 v20, v[76:79] offset:41984
    v_pk_mul_f32 v[32:33], v[200:201], v[200:201]
    v_pk_mul_f32 v[34:35], v[202:203], v[202:203]
    v_pk_fma_f32 v[32:33], v[32:33], s[46:47], s[46:47] op_sel:[0,0,1] op_sel_hi:[1,0,1]
    v_pk_fma_f32 v[34:35], v[34:35], s[46:47], s[46:47] op_sel:[0,0,1] op_sel_hi:[1,0,1]
    v_pk_mul_f32 v[32:33], v[32:33], v[200:201]
    v_pk_mul_f32 v[34:35], v[34:35], v[202:203]
    v_exp_f32 v32, v32
    v_exp_f32 v33, v33
    v_exp_f32 v34, v34
    v_exp_f32 v35, v35
    v_pk_add_f32 v[32:33], v[32:33], 1.0 op_sel_hi:[1,0]
    v_pk_add_f32 v[34:35], v[34:35], 1.0 op_sel_hi:[1,0]
    v_rcp_f32 v32, v32
    v_rcp_f32 v33, v33
    v_rcp_f32 v34, v34
    v_rcp_f32 v35, v35
    v_pk_mul_f32 v[32:33], v[32:33], v[200:201]
    v_pk_mul_f32 v[34:35], v[34:35], v[202:203]
    v_cvt_pk_bf16_f32 v80, v32, v33
    v_cvt_pk_bf16_f32 v81, v34, v35
    v_pk_mul_f32 v[36:37], v[216:217], v[216:217]
    v_pk_mul_f32 v[38:39], v[218:219], v[218:219]
    v_pk_fma_f32 v[36:37], v[36:37], s[46:47], s[46:47] op_sel:[0,0,1] op_sel_hi:[1,0,1]
    v_pk_fma_f32 v[38:39], v[38:39], s[46:47], s[46:47] op_sel:[0,0,1] op_sel_hi:[1,0,1]
    v_pk_mul_f32 v[36:37], v[36:37], v[216:217]
    v_pk_mul_f32 v[38:39], v[38:39], v[218:219]
    v_exp_f32 v36, v36
    v_exp_f32 v37, v37
    v_exp_f32 v38, v38
    v_exp_f32 v39, v39
    v_pk_add_f32 v[36:37], v[36:37], 1.0 op_sel_hi:[1,0]
    v_pk_add_f32 v[38:39], v[38:39], 1.0 op_sel_hi:[1,0]
    v_rcp_f32 v36, v36
    v_rcp_f32 v37, v37
    v_rcp_f32 v38, v38
    v_rcp_f32 v39, v39
    v_pk_mul_f32 v[36:37], v[36:37], v[216:217]
    v_pk_mul_f32 v[38:39], v[38:39], v[218:219]
    v_cvt_pk_bf16_f32 v82, v36, v37
    v_cvt_pk_bf16_f32 v83, v38, v39
    buffer_store_dwordx4 v[80:83], v14, s[32:35], s53 offen offset:2048 sc1
    ds_write_b128 v20, v[80:83] offset:43008
    v_pk_mul_f32 v[32:33], v[204:205], v[204:205]
    v_pk_mul_f32 v[34:35], v[206:207], v[206:207]
    v_pk_fma_f32 v[32:33], v[32:33], s[46:47], s[46:47] op_sel:[0,0,1] op_sel_hi:[1,0,1]
    v_pk_fma_f32 v[34:35], v[34:35], s[46:47], s[46:47] op_sel:[0,0,1] op_sel_hi:[1,0,1]
    v_pk_mul_f32 v[32:33], v[32:33], v[204:205]
    v_pk_mul_f32 v[34:35], v[34:35], v[206:207]
    v_exp_f32 v32, v32
    v_exp_f32 v33, v33
    v_exp_f32 v34, v34
    v_exp_f32 v35, v35
    v_pk_add_f32 v[32:33], v[32:33], 1.0 op_sel_hi:[1,0]
    v_pk_add_f32 v[34:35], v[34:35], 1.0 op_sel_hi:[1,0]
    v_rcp_f32 v32, v32
    v_rcp_f32 v33, v33
    v_rcp_f32 v34, v34
    v_rcp_f32 v35, v35
    v_pk_mul_f32 v[32:33], v[32:33], v[204:205]
    v_pk_mul_f32 v[34:35], v[34:35], v[206:207]
    v_cvt_pk_bf16_f32 v84, v32, v33
    v_cvt_pk_bf16_f32 v85, v34, v35
    v_pk_mul_f32 v[36:37], v[220:221], v[220:221]
    v_pk_mul_f32 v[38:39], v[222:223], v[222:223]
    v_pk_fma_f32 v[36:37], v[36:37], s[46:47], s[46:47] op_sel:[0,0,1] op_sel_hi:[1,0,1]
    v_pk_fma_f32 v[38:39], v[38:39], s[46:47], s[46:47] op_sel:[0,0,1] op_sel_hi:[1,0,1]
    v_pk_mul_f32 v[36:37], v[36:37], v[220:221]
    v_pk_mul_f32 v[38:39], v[38:39], v[222:223]
    v_exp_f32 v36, v36
    v_exp_f32 v37, v37
    v_exp_f32 v38, v38
    v_exp_f32 v39, v39
    v_pk_add_f32 v[36:37], v[36:37], 1.0 op_sel_hi:[1,0]
    v_pk_add_f32 v[38:39], v[38:39], 1.0 op_sel_hi:[1,0]
    v_rcp_f32 v36, v36
    v_rcp_f32 v37, v37
    v_rcp_f32 v38, v38
    v_rcp_f32 v39, v39
    v_pk_mul_f32 v[36:37], v[36:37], v[220:221]
    v_pk_mul_f32 v[38:39], v[38:39], v[222:223]
    v_cvt_pk_bf16_f32 v86, v36, v37
    v_cvt_pk_bf16_f32 v87, v38, v39
    buffer_store_dwordx4 v[84:87], v14, s[32:35], s53 offen offset:3072 sc1
    ds_write_b128 v20, v[84:87] offset:44032
    s_lshr_b32 s40, s21, 3
    s_and_b32 s41, s21, 7
    v_and_b32 v15, 1, v13
    v_lshrrev_b32 v17, 1, v13
    s_lshl_b32 s42, s3, 11
    v_lshlrev_b32 v16, 4, v12
    v_lshl_add_u32 v16, v15, 10, v16
    v_lshl_add_u32 v16, v17, 8, v16
    v_add_u32 v16, s42, v16
    v_readlane_b32 s88, v25, 7
    v_readlane_b32 s89, v25, 8
    v_readlane_b32 s90, v25, 9
    v_readlane_b32 s91, v25, 10
    v_readlane_b32 s92, v25, 11
    v_readlane_b32 s93, v25, 12
    v_readlane_b32 s94, v25, 13
    v_readlane_b32 s95, v25, 14
    v_readlane_b32 s66, v25, 15
    s_mov_b32 s45, 15
    v_lshrrev_b32 v3, 2, v12
    v_lshl_add_u32 v4, v17, 2, v3
    v_lshlrev_b32 v4, 8, v4
    v_lshl_add_u32 v3, v3, 1, v15
    v_lshl_add_u32 v4, v3, 5, v4
    v_and_b32 v3, 3, v2
    v_lshl_add_u32 v4, v3, 3, v4
    s_lshl_b32 s43, s40, 7
    v_xor_b32 v4, s43, v4
    v_xor_b32 v5, 64, v4
    v_xor_b32 v6, 128, v4
    v_xor_b32 v7, 192, v4
    v_sub_u32 v19, s41, v2
    v_and_b32 v19, 7, v19
    v_lshlrev_b32 v19, 2, v19
    v_lshl_add_u32 v19, v2, 10, v19
    s_and_b32 s46, s67, 0xf8
    s_lshl_b32 s46, s46, 10
    s_add_u32 s46, s46, 50331648
    s_waitcnt vmcnt(14)
    v_lshlrev_b32 v32, 16, v96
    v_and_b32 v33, 0xffff0000, v96
    v_lshlrev_b32 v34, 16, v97
    v_and_b32 v35, 0xffff0000, v97
    v_lshlrev_b32 v36, 16, v98
    v_and_b32 v37, 0xffff0000, v98
    v_lshlrev_b32 v38, 16, v99
    v_and_b32 v39, 0xffff0000, v99
    v_lshlrev_b32 v40, 16, v100
    v_and_b32 v41, 0xffff0000, v100
    v_lshlrev_b32 v42, 16, v101
    v_and_b32 v43, 0xffff0000, v101
    v_lshlrev_b32 v44, 16, v102
    v_and_b32 v45, 0xffff0000, v102
    v_lshlrev_b32 v46, 16, v103
    v_and_b32 v47, 0xffff0000, v103
    v_lshlrev_b32 v48, 16, v104
    v_and_b32 v49, 0xffff0000, v104
    v_lshlrev_b32 v50, 16, v105
    v_and_b32 v51, 0xffff0000, v105
    v_lshlrev_b32 v52, 16, v106
    v_and_b32 v53, 0xffff0000, v106
    v_lshlrev_b32 v54, 16, v107
    v_and_b32 v55, 0xffff0000, v107
    v_lshlrev_b32 v56, 16, v108
    v_and_b32 v57, 0xffff0000, v108
    v_lshlrev_b32 v58, 16, v109
    v_and_b32 v59, 0xffff0000, v109
    v_lshlrev_b32 v60, 16, v110
    v_and_b32 v61, 0xffff0000, v110
    v_lshlrev_b32 v62, 16, v111
    v_and_b32 v63, 0xffff0000, v111
    v_add_u32 v22, 98304, v16
    v_mov_b32 v23, 160000
    s_cmp_lg_u32 s3, 0
    s_waitcnt vmcnt(8) lgkmcnt(0)
    s_barrier
    s_cbranch_scc1 L_NOPUBA
    s_mov_b64 exec, 255
    buffer_store_dword v18, v19, s[32:35], s46 offen sc1
    s_mov_b64 exec, -1
L_NOPUBA:
    ds_read_b128 v[160:163], v22 offset:0
    ds_read_b128 v[164:167], v22 offset:512
    ds_read_b128 v[168:171], v22 offset:8192
    ds_read_b128 v[172:175], v22 offset:8704
    ds_read_b128 v[176:179], v22 offset:16384
    ds_read_b128 v[180:183], v22 offset:16896
    ds_read_b128 v[184:187], v22 offset:24576
    ds_read_b128 v[188:191], v22 offset:25088
    ds_read_b128 v[192:195], v22 offset:32768
    ds_read_b128 v[196:199], v22 offset:33280
    ds_read_b128 v[200:203], v22 offset:40960
    ds_read_b128 v[204:207], v22 offset:41472
    ds_read_b128 v[208:211], v22 offset:49152
    ds_read_b128 v[212:215], v22 offset:49664
    ds_read_b64_tr_b16 v[96:97], v4 offset:0
    ds_read_b64_tr_b16 v[98:99], v4 offset:4096
    ds_read_b64_tr_b16 v[100:101], v5 offset:0
    ds_read_b64_tr_b16 v[102:103], v5 offset:4096
    ds_read_b64_tr_b16 v[104:105], v6 offset:0
    ds_read_b64_tr_b16 v[106:107], v6 offset:4096
    ds_read_b64_tr_b16 v[108:109], v7 offset:0
    ds_read_b64_tr_b16 v[110:111], v7 offset:4096
    ds_read_b64_tr_b16 v[112:113], v4 offset:2048
    ds_read_b64_tr_b16 v[114:115], v4 offset:6144
    ds_read_b64_tr_b16 v[116:117], v5 offset:2048
    ds_read_b64_tr_b16 v[118:119], v5 offset:6144
    ds_read_b64_tr_b16 v[120:121], v6 offset:2048
    ds_read_b64_tr_b16 v[122:123], v6 offset:6144
    ds_read_b64_tr_b16 v[124:125], v7 offset:2048
    ds_read_b64_tr_b16 v[126:127], v7 offset:6144
    v_pk_mov_b32 v[64:65], 0, 0
    v_pk_mov_b32 v[66:67], 0, 0
    v_pk_mov_b32 v[68:69], 0, 0
    v_pk_mov_b32 v[70:71], 0, 0
    v_pk_mov_b32 v[72:73], 0, 0
    v_pk_mov_b32 v[74:75], 0, 0
    v_pk_mov_b32 v[76:77], 0, 0
    v_pk_mov_b32 v[78:79], 0, 0
    v_pk_mov_b32 v[80:81], 0, 0
    v_pk_mov_b32 v[82:83], 0, 0
    v_pk_mov_b32 v[84:85], 0, 0
    v_pk_mov_b32 v[86:87], 0, 0
    v_pk_mov_b32 v[88:89], 0, 0
    v_pk_mov_b32 v[90:91], 0, 0
    v_pk_mov_b32 v[92:93], 0, 0
    v_pk_mov_b32 v[94:95], 0, 0
    s_mov_b32 s36, s14
    s_and_b32 s37, s15, 0xffff
    s_mov_b32 s38, 4194304
    s_mov_b32 s39, 0x20000
    s_waitcnt lgkmcnt(14)
    v_mfma_f32_32x32x16_bf16 v[32:47], v[96:99], v[160:163], v[32:47]
    s_waitcnt lgkmcnt(12)
    v_mfma_f32_32x32x16_bf16 v[48:63], v[100:103], v[160:163], v[48:63]
    ds_read_b64_tr_b16 v[128:129], v4 offset:8192
    ds_read_b64_tr_b16 v[130:131], v4 offset:12288
    ds_read_b64_tr_b16 v[132:133], v5 offset:8192
    s_waitcnt lgkmcnt(13)
    v_mfma_f32_32x32x16_bf16 v[64:79], v[104:107], v[160:163], v[64:79]
    ds_read_b64_tr_b16 v[134:135], v5 offset:12288
    ds_read_b64_tr_b16 v[136:137], v6 offset:8192
    ds_read_b64_tr_b16 v[138:139], v6 offset:12288
    s_waitcnt lgkmcnt(14)
    v_mfma_f32_32x32x16_bf16 v[80:95], v[108:111], v[160:163], v[80:95]
    ds_read_b64_tr_b16 v[140:141], v7 offset:8192
    ds_read_b64_tr_b16 v[142:143], v7 offset:12288
    s_waitcnt lgkmcnt(14)
    v_mfma_f32_32x32x16_bf16 v[32:47], v[112:115], v[164:167], v[32:47]
    s_waitcnt lgkmcnt(12)
    v_mfma_f32_32x32x16_bf16 v[48:63], v[116:119], v[164:167], v[48:63]
    ds_read_b64_tr_b16 v[144:145], v4 offset:10240
    ds_read_b64_tr_b16 v[146:147], v4 offset:14336
    ds_read_b64_tr_b16 v[148:149], v5 offset:10240
    s_waitcnt lgkmcnt(13)
    v_mfma_f32_32x32x16_bf16 v[64:79], v[120:123], v[164:167], v[64:79]
    ds_read_b64_tr_b16 v[150:151], v5 offset:14336
    ds_read_b64_tr_b16 v[152:153], v6 offset:10240
    ds_read_b64_tr_b16 v[154:155], v6 offset:14336
    s_waitcnt lgkmcnt(14)
    v_mfma_f32_32x32x16_bf16 v[80:95], v[124:127], v[164:167], v[80:95]
    ds_read_b64_tr_b16 v[156:157], v7 offset:10240
    ds_read_b64_tr_b16 v[158:159], v7 offset:14336
    s_barrier
    s_waitcnt lgkmcnt(14)
    v_mfma_f32_32x32x16_bf16 v[32:47], v[128:131], v[168:171], v[32:47]
    s_waitcnt lgkmcnt(12)
    v_mfma_f32_32x32x16_bf16 v[48:63], v[132:135], v[168:171], v[48:63]
    ds_read_b64_tr_b16 v[96:97], v4 offset:16384
    ds_read_b64_tr_b16 v[98:99], v4 offset:20480
    ds_read_b64_tr_b16 v[100:101], v5 offset:16384
    s_waitcnt lgkmcnt(13)
    v_mfma_f32_32x32x16_bf16 v[64:79], v[136:139], v[168:171], v[64:79]
    ds_read_b64_tr_b16 v[102:103], v5 offset:20480
    ds_read_b64_tr_b16 v[104:105], v6 offset:16384
    ds_read_b64_tr_b16 v[106:107], v6 offset:20480
    s_waitcnt lgkmcnt(14)
    v_mfma_f32_32x32x16_bf16 v[80:95], v[140:143], v[168:171], v[80:95]
    ds_read_b64_tr_b16 v[108:109], v7 offset:16384
    ds_read_b64_tr_b16 v[110:111], v7 offset:20480
    s_waitcnt lgkmcnt(14)
    v_mfma_f32_32x32x16_bf16 v[32:47], v[144:147], v[172:175], v[32:47]
    s_waitcnt lgkmcnt(12)
    v_mfma_f32_32x32x16_bf16 v[48:63], v[148:151], v[172:175], v[48:63]
    ds_read_b64_tr_b16 v[112:113], v4 offset:18432
    ds_read_b64_tr_b16 v[114:115], v4 offset:22528
    ds_read_b64_tr_b16 v[116:117], v5 offset:18432
    s_waitcnt lgkmcnt(13)
    v_mfma_f32_32x32x16_bf16 v[64:79], v[152:155], v[172:175], v[64:79]
    ds_read_b64_tr_b16 v[118:119], v5 offset:22528
    ds_read_b64_tr_b16 v[120:121], v6 offset:18432
    ds_read_b64_tr_b16 v[122:123], v6 offset:22528
    s_waitcnt lgkmcnt(14)
    v_mfma_f32_32x32x16_bf16 v[80:95], v[156:159], v[172:175], v[80:95]
    ds_read_b64_tr_b16 v[124:125], v7 offset:18432
    ds_read_b64_tr_b16 v[126:127], v7 offset:22528
    s_waitcnt lgkmcnt(14)
    v_mfma_f32_32x32x16_bf16 v[32:47], v[96:99], v[176:179], v[32:47]
    s_waitcnt lgkmcnt(12)
    v_mfma_f32_32x32x16_bf16 v[48:63], v[100:103], v[176:179], v[48:63]
    ds_read_b64_tr_b16 v[128:129], v4 offset:24576
    ds_read_b64_tr_b16 v[130:131], v4 offset:28672
    ds_read_b64_tr_b16 v[132:133], v5 offset:24576
    s_waitcnt lgkmcnt(13)
    v_mfma_f32_32x32x16_bf16 v[64:79], v[104:107], v[176:179], v[64:79]
    ds_read_b64_tr_b16 v[134:135], v5 offset:28672
    ds_read_b64_tr_b16 v[136:137], v6 offset:24576
    ds_read_b64_tr_b16 v[138:139], v6 offset:28672
    s_waitcnt lgkmcnt(14)
    v_mfma_f32_32x32x16_bf16 v[80:95], v[108:111], v[176:179], v[80:95]
    ds_read_b64_tr_b16 v[140:141], v7 offset:24576
    ds_read_b64_tr_b16 v[142:143], v7 offset:28672
    s_waitcnt lgkmcnt(14)
    v_mfma_f32_32x32x16_bf16 v[32:47], v[112:115], v[180:183], v[32:47]
    s_waitcnt lgkmcnt(12)
    v_mfma_f32_32x32x16_bf16 v[48:63], v[116:119], v[180:183], v[48:63]
    ds_read_b64_tr_b16 v[144:145], v4 offset:26624
    ds_read_b64_tr_b16 v[146:147], v4 offset:30720
    ds_read_b64_tr_b16 v[148:149], v5 offset:26624
    s_waitcnt lgkmcnt(13)
    v_mfma_f32_32x32x16_bf16 v[64:79], v[120:123], v[180:183], v[64:79]
    ds_read_b64_tr_b16 v[150:151], v5 offset:30720
    ds_read_b64_tr_b16 v[152:153], v6 offset:26624
    ds_read_b64_tr_b16 v[154:155], v6 offset:30720
    s_waitcnt lgkmcnt(14)
    v_mfma_f32_32x32x16_bf16 v[80:95], v[124:127], v[180:183], v[80:95]
    ds_read_b64_tr_b16 v[156:157], v7 offset:26624
    ds_read_b64_tr_b16 v[158:159], v7 offset:30720
    s_barrier
    buffer_load_dwordx4 v[216:219], v16, s[32:35], s88 offen sc1
    buffer_load_dwordx4 v[220:223], v16, s[32:35], s88 offen offset:512 sc1
    buffer_load_dwordx4 v[160:163], v16, s[32:35], s89 offen sc1
    buffer_load_dwordx4 v[164:167], v16, s[32:35], s89 offen offset:512 sc1
    buffer_load_dwordx4 v[168:171], v16, s[32:35], s90 offen sc1
    buffer_load_dwordx4 v[172:175], v16, s[32:35], s90 offen offset:512 sc1
    buffer_load_dwordx4 v[176:179], v16, s[32:35], s91 offen sc1
    buffer_load_dwordx4 v[180:183], v16, s[32:35], s91 offen offset:512 sc1
    s_waitcnt lgkmcnt(14)
    v_mfma_f32_32x32x16_bf16 v[32:47], v[128:131], v[184:187], v[32:47]
    s_waitcnt lgkmcnt(12)
    v_mfma_f32_32x32x16_bf16 v[48:63], v[132:135], v[184:187], v[48:63]
    ds_read_b64_tr_b16 v[96:97], v4 offset:32768
    ds_read_b64_tr_b16 v[98:99], v4 offset:36864
    ds_read_b64_tr_b16 v[100:101], v5 offset:32768
    s_waitcnt lgkmcnt(13)
    v_mfma_f32_32x32x16_bf16 v[64:79], v[136:139], v[184:187], v[64:79]
    ds_read_b64_tr_b16 v[102:103], v5 offset:36864
    ds_read_b64_tr_b16 v[104:105], v6 offset:32768
    ds_read_b64_tr_b16 v[106:107], v6 offset:36864
    s_waitcnt lgkmcnt(14)
    v_mfma_f32_32x32x16_bf16 v[80:95], v[140:143], v[184:187], v[80:95]
    ds_read_b64_tr_b16 v[108:109], v7 offset:32768
    ds_read_b64_tr_b16 v[110:111], v7 offset:36864
    s_waitcnt lgkmcnt(14)
    v_mfma_f32_32x32x16_bf16 v[32:47], v[144:147], v[188:191], v[32:47]
    s_waitcnt lgkmcnt(12)
    v_mfma_f32_32x32x16_bf16 v[48:63], v[148:151], v[188:191], v[48:63]
    ds_read_b64_tr_b16 v[112:113], v4 offset:34816
    ds_read_b64_tr_b16 v[114:115], v4 offset:38912
    ds_read_b64_tr_b16 v[116:117], v5 offset:34816
    s_waitcnt lgkmcnt(13)
    v_mfma_f32_32x32x16_bf16 v[64:79], v[152:155], v[188:191], v[64:79]
    ds_read_b64_tr_b16 v[118:119], v5 offset:38912
    ds_read_b64_tr_b16 v[120:121], v6 offset:34816
    ds_read_b64_tr_b16 v[122:123], v6 offset:38912
    s_waitcnt lgkmcnt(14)
    v_mfma_f32_32x32x16_bf16 v[80:95], v[156:159], v[188:191], v[80:95]
    ds_read_b64_tr_b16 v[124:125], v7 offset:34816
    ds_read_b64_tr_b16 v[126:127], v7 offset:38912
    buffer_load_dwordx4 v[184:187], v16, s[32:35], s92 offen sc1
    buffer_load_dwordx4 v[188:191], v16, s[32:35], s92 offen offset:512 sc1
    s_waitcnt lgkmcnt(14)
    v_mfma_f32_32x32x16_bf16 v[32:47], v[96:99], v[192:195], v[32:47]
    s_waitcnt lgkmcnt(12)
    v_mfma_f32_32x32x16_bf16 v[48:63], v[100:103], v[192:195], v[48:63]
    ds_read_b64_tr_b16 v[128:129], v4 offset:40960
    ds_read_b64_tr_b16 v[130:131], v4 offset:45056
    ds_read_b64_tr_b16 v[132:133], v5 offset:40960
    s_waitcnt lgkmcnt(13)
    v_mfma_f32_32x32x16_bf16 v[64:79], v[104:107], v[192:195], v[64:79]
    ds_read_b64_tr_b16 v[134:135], v5 offset:45056
    ds_read_b64_tr_b16 v[136:137], v6 offset:40960
    ds_read_b64_tr_b16 v[138:139], v6 offset:45056
    s_waitcnt lgkmcnt(14)
    v_mfma_f32_32x32x16_bf16 v[80:95], v[108:111], v[192:195], v[80:95]
    ds_read_b64_tr_b16 v[140:141], v7 offset:40960
    ds_read_b64_tr_b16 v[142:143], v7 offset:45056
    s_waitcnt lgkmcnt(14)
    v_mfma_f32_32x32x16_bf16 v[32:47], v[112:115], v[196:199], v[32:47]
    s_waitcnt lgkmcnt(12)
    v_mfma_f32_32x32x16_bf16 v[48:63], v[116:119], v[196:199], v[48:63]
    ds_read_b64_tr_b16 v[144:145], v4 offset:43008
    ds_read_b64_tr_b16 v[146:147], v4 offset:47104
    ds_read_b64_tr_b16 v[148:149], v5 offset:43008
    s_waitcnt lgkmcnt(13)
    v_mfma_f32_32x32x16_bf16 v[64:79], v[120:123], v[196:199], v[64:79]
    ds_read_b64_tr_b16 v[150:151], v5 offset:47104
    ds_read_b64_tr_b16 v[152:153], v6 offset:43008
    ds_read_b64_tr_b16 v[154:155], v6 offset:47104
    s_waitcnt lgkmcnt(14)
    v_mfma_f32_32x32x16_bf16 v[80:95], v[124:127], v[196:199], v[80:95]
    ds_read_b64_tr_b16 v[156:157], v7 offset:43008
    ds_read_b64_tr_b16 v[158:159], v7 offset:47104
    s_waitcnt vmcnt(10)
    s_mov_b64 exec, 1
    ds_add_rtn_u32 v24, v23, v18
    s_mov_b64 exec, 255
    s_waitcnt lgkmcnt(0)
    v_readfirstlane_b32 s47, v24
    s_cmp_lg_u32 s47, 3
    s_cbranch_scc1 L_NOPUB
    buffer_store_dword v18, v19, s[32:35], s46 offen offset:32 sc1
L_NOPUB:
    s_mov_b64 exec, -1
    s_barrier
    buffer_load_dwordx4 v[192:195], v16, s[32:35], s93 offen sc1
    buffer_load_dwordx4 v[196:199], v16, s[32:35], s93 offen offset:512 sc1
    s_waitcnt lgkmcnt(14)
    v_mfma_f32_32x32x16_bf16 v[32:47], v[128:131], v[200:203], v[32:47]
    s_waitcnt lgkmcnt(12)
    v_mfma_f32_32x32x16_bf16 v[48:63], v[132:135], v[200:203], v[48:63]
    ds_read_b64_tr_b16 v[96:97], v4 offset:49152
    ds_read_b64_tr_b16 v[98:99], v4 offset:53248
    ds_read_b64_tr_b16 v[100:101], v5 offset:49152
    s_waitcnt lgkmcnt(13)
    v_mfma_f32_32x32x16_bf16 v[64:79], v[136:139], v[200:203], v[64:79]
    ds_read_b64_tr_b16 v[102:103], v5 offset:53248
    ds_read_b64_tr_b16 v[104:105], v6 offset:49152
    ds_read_b64_tr_b16 v[106:107], v6 offset:53248
    s_waitcnt lgkmcnt(14)
    v_mfma_f32_32x32x16_bf16 v[80:95], v[140:143], v[200:203], v[80:95]
    ds_read_b64_tr_b16 v[108:109], v7 offset:49152
    ds_read_b64_tr_b16 v[110:111], v7 offset:53248
    s_waitcnt lgkmcnt(14)
    v_mfma_f32_32x32x16_bf16 v[32:47], v[144:147], v[204:207], v[32:47]
    s_waitcnt lgkmcnt(12)
    v_mfma_f32_32x32x16_bf16 v[48:63], v[148:151], v[204:207], v[48:63]
    ds_read_b64_tr_b16 v[112:113], v4 offset:51200
    ds_read_b64_tr_b16 v[114:115], v4 offset:55296
    ds_read_b64_tr_b16 v[116:117], v5 offset:51200
    s_waitcnt lgkmcnt(13)
    v_mfma_f32_32x32x16_bf16 v[64:79], v[152:155], v[204:207], v[64:79]
    ds_read_b64_tr_b16 v[118:119], v5 offset:55296
    ds_read_b64_tr_b16 v[120:121], v6 offset:51200
    ds_read_b64_tr_b16 v[122:123], v6 offset:55296
    s_waitcnt lgkmcnt(14)
    v_mfma_f32_32x32x16_bf16 v[80:95], v[156:159], v[204:207], v[80:95]
    ds_read_b64_tr_b16 v[124:125], v7 offset:51200
    ds_read_b64_tr_b16 v[126:127], v7 offset:55296
    buffer_load_dwordx4 v[200:203], v16, s[32:35], s94 offen sc1
    buffer_load_dwordx4 v[204:207], v16, s[32:35], s94 offen offset:512 sc1
    s_waitcnt lgkmcnt(14)
    v_mfma_f32_32x32x16_bf16 v[32:47], v[96:99], v[208:211], v[32:47]
    s_waitcnt lgkmcnt(12)
    v_mfma_f32_32x32x16_bf16 v[48:63], v[100:103], v[208:211], v[48:63]
    ds_read_b64_tr_b16 v[128:129], v4 offset:57344
    ds_read_b64_tr_b16 v[130:131], v4 offset:61440
    ds_read_b64_tr_b16 v[132:133], v5 offset:57344
    s_waitcnt lgkmcnt(13)
    v_mfma_f32_32x32x16_bf16 v[64:79], v[104:107], v[208:211], v[64:79]
    ds_read_b64_tr_b16 v[134:135], v5 offset:61440
    ds_read_b64_tr_b16 v[136:137], v6 offset:57344
    ds_read_b64_tr_b16 v[138:139], v6 offset:61440
    s_waitcnt lgkmcnt(14)
    v_mfma_f32_32x32x16_bf16 v[80:95], v[108:111], v[208:211], v[80:95]
    ds_read_b64_tr_b16 v[140:141], v7 offset:57344
    ds_read_b64_tr_b16 v[142:143], v7 offset:61440
    s_waitcnt lgkmcnt(14)
    v_mfma_f32_32x32x16_bf16 v[32:47], v[112:115], v[212:215], v[32:47]
    s_waitcnt lgkmcnt(12)
    v_mfma_f32_32x32x16_bf16 v[48:63], v[116:119], v[212:215], v[48:63]
    ds_read_b64_tr_b16 v[144:145], v4 offset:59392
    ds_read_b64_tr_b16 v[146:147], v4 offset:63488
    ds_read_b64_tr_b16 v[148:149], v5 offset:59392
    s_waitcnt lgkmcnt(13)
    v_mfma_f32_32x32x16_bf16 v[64:79], v[120:123], v[212:215], v[64:79]
    ds_read_b64_tr_b16 v[150:151], v5 offset:63488
    ds_read_b64_tr_b16 v[152:153], v6 offset:59392
    ds_read_b64_tr_b16 v[154:155], v6 offset:63488
    s_waitcnt lgkmcnt(14)
    v_mfma_f32_32x32x16_bf16 v[80:95], v[124:127], v[212:215], v[80:95]
    ds_read_b64_tr_b16 v[156:157], v7 offset:59392
    ds_read_b64_tr_b16 v[158:159], v7 offset:63488
    s_barrier
    buffer_load_dwordx4 v[208:211], v16, s[32:35], s95 offen sc1
    buffer_load_dwordx4 v[212:215], v16, s[32:35], s95 offen offset:512 sc1
    s_waitcnt vmcnt(14)
    s_waitcnt lgkmcnt(14)
    v_mfma_f32_32x32x16_bf16 v[32:47], v[128:131], v[216:219], v[32:47]
    s_waitcnt lgkmcnt(12)
    v_mfma_f32_32x32x16_bf16 v[48:63], v[132:135], v[216:219], v[48:63]
    v_xor_b32 v4, 0x10000, v4
    ds_read_b64_tr_b16 v[96:97], v4 offset:0
    ds_read_b64_tr_b16 v[98:99], v4 offset:4096
    v_xor_b32 v5, 0x10000, v5
    ds_read_b64_tr_b16 v[100:101], v5 offset:0
    s_waitcnt lgkmcnt(13)
    v_mfma_f32_32x32x16_bf16 v[64:79], v[136:139], v[216:219], v[64:79]
    ds_read_b64_tr_b16 v[102:103], v5 offset:4096
    v_xor_b32 v6, 0x10000, v6
    ds_read_b64_tr_b16 v[104:105], v6 offset:0
    ds_read_b64_tr_b16 v[106:107], v6 offset:4096
    s_waitcnt lgkmcnt(14)
    v_mfma_f32_32x32x16_bf16 v[80:95], v[140:143], v[216:219], v[80:95]
    v_xor_b32 v7, 0x10000, v7
    ds_read_b64_tr_b16 v[108:109], v7 offset:0
    ds_read_b64_tr_b16 v[110:111], v7 offset:4096
    s_waitcnt lgkmcnt(14)
    v_mfma_f32_32x32x16_bf16 v[32:47], v[144:147], v[220:223], v[32:47]
    s_waitcnt lgkmcnt(12)
    v_mfma_f32_32x32x16_bf16 v[48:63], v[148:151], v[220:223], v[48:63]
    ds_read_b64_tr_b16 v[112:113], v4 offset:2048
    ds_read_b64_tr_b16 v[114:115], v4 offset:6144
    ds_read_b64_tr_b16 v[116:117], v5 offset:2048
    s_waitcnt lgkmcnt(13)
    v_mfma_f32_32x32x16_bf16 v[64:79], v[152:155], v[220:223], v[64:79]
    ds_read_b64_tr_b16 v[118:119], v5 offset:6144
    ds_read_b64_tr_b16 v[120:121], v6 offset:2048
    ds_read_b64_tr_b16 v[122:123], v6 offset:6144
    s_waitcnt lgkmcnt(14)
    v_mfma_f32_32x32x16_bf16 v[80:95], v[156:159], v[220:223], v[80:95]
    ds_read_b64_tr_b16 v[124:125], v7 offset:2048
    ds_read_b64_tr_b16 v[126:127], v7 offset:6144
    s_mov_b32 s60, 0
L_LOOP2:
    s_waitcnt vmcnt(12)
    s_waitcnt lgkmcnt(14)
    v_mfma_f32_32x32x16_bf16 v[32:47], v[96:99], v[160:163], v[32:47]
    buffer_load_dwordx4 v[216:219], v16, s[32:35], s66 offen sc1
    s_waitcnt lgkmcnt(12)
    v_mfma_f32_32x32x16_bf16 v[48:63], v[100:103], v[160:163], v[48:63]
    ds_read_b64_tr_b16 v[128:129], v4 offset:8192
    ds_read_b64_tr_b16 v[130:131], v4 offset:12288
    ds_read_b64_tr_b16 v[132:133], v5 offset:8192
    s_waitcnt lgkmcnt(13)
    v_mfma_f32_32x32x16_bf16 v[64:79], v[104:107], v[160:163], v[64:79]
    ds_read_b64_tr_b16 v[134:135], v5 offset:12288
    ds_read_b64_tr_b16 v[136:137], v6 offset:8192
    ds_read_b64_tr_b16 v[138:139], v6 offset:12288
    s_waitcnt lgkmcnt(14)
    v_mfma_f32_32x32x16_bf16 v[80:95], v[108:111], v[160:163], v[80:95]
    ds_read_b64_tr_b16 v[140:141], v7 offset:8192
    ds_read_b64_tr_b16 v[142:143], v7 offset:12288
    s_waitcnt lgkmcnt(14)
    v_mfma_f32_32x32x16_bf16 v[32:47], v[112:115], v[164:167], v[32:47]
    buffer_load_dwordx4 v[220:223], v16, s[32:35], s66 offen offset:512 sc1
    s_add_u32 s45, s45, 1
    v_readlane_b32 s66, v25, s45
    s_waitcnt lgkmcnt(12)
    v_mfma_f32_32x32x16_bf16 v[48:63], v[116:119], v[164:167], v[48:63]
    ds_read_b64_tr_b16 v[144:145], v4 offset:10240
    ds_read_b64_tr_b16 v[146:147], v4 offset:14336
    ds_read_b64_tr_b16 v[148:149], v5 offset:10240
    s_waitcnt lgkmcnt(13)
    v_mfma_f32_32x32x16_bf16 v[64:79], v[120:123], v[164:167], v[64:79]
    ds_read_b64_tr_b16 v[150:151], v5 offset:14336
    ds_read_b64_tr_b16 v[152:153], v6 offset:10240
    ds_read_b64_tr_b16 v[154:155], v6 offset:14336
    s_waitcnt lgkmcnt(14)
    v_mfma_f32_32x32x16_bf16 v[80:95], v[124:127], v[164:167], v[80:95]
    ds_read_b64_tr_b16 v[156:157], v7 offset:10240
    ds_read_b64_tr_b16 v[158:159], v7 offset:14336
    s_waitcnt vmcnt(12)
    s_waitcnt lgkmcnt(14)
    v_mfma_f32_32x32x16_bf16 v[32:47], v[128:131], v[168:171], v[32:47]
    buffer_load_dwordx4 v[160:163], v16, s[32:35], s66 offen sc1
    s_barrier
    s_waitcnt lgkmcnt(12)
    v_mfma_f32_32x32x16_bf16 v[48:63], v[132:135], v[168:171], v[48:63]
    ds_read_b64_tr_b16 v[96:97], v4 offset:16384
    ds_read_b64_tr_b16 v[98:99], v4 offset:20480
    ds_read_b64_tr_b16 v[100:101], v5 offset:16384
    s_waitcnt lgkmcnt(13)
    v_mfma_f32_32x32x16_bf16 v[64:79], v[136:139], v[168:171], v[64:79]
    ds_read_b64_tr_b16 v[102:103], v5 offset:20480
    ds_read_b64_tr_b16 v[104:105], v6 offset:16384
    ds_read_b64_tr_b16 v[106:107], v6 offset:20480
    s_waitcnt lgkmcnt(14)
    v_mfma_f32_32x32x16_bf16 v[80:95], v[140:143], v[168:171], v[80:95]
    ds_read_b64_tr_b16 v[108:109], v7 offset:16384
    ds_read_b64_tr_b16 v[110:111], v7 offset:20480
    s_waitcnt lgkmcnt(14)
    v_mfma_f32_32x32x16_bf16 v[32:47], v[144:147], v[172:175], v[32:47]
    buffer_load_dwordx4 v[164:167], v16, s[32:35], s66 offen offset:512 sc1
    s_add_u32 s45, s45, 1
    v_readlane_b32 s66, v25, s45
    s_waitcnt lgkmcnt(12)
    v_mfma_f32_32x32x16_bf16 v[48:63], v[148:151], v[172:175], v[48:63]
    ds_read_b64_tr_b16 v[112:113], v4 offset:18432
    ds_read_b64_tr_b16 v[114:115], v4 offset:22528
    ds_read_b64_tr_b16 v[116:117], v5 offset:18432
    s_waitcnt lgkmcnt(13)
    v_mfma_f32_32x32x16_bf16 v[64:79], v[152:155], v[172:175], v[64:79]
    ds_read_b64_tr_b16 v[118:119], v5 offset:22528
    ds_read_b64_tr_b16 v[120:121], v6 offset:18432
    ds_read_b64_tr_b16 v[122:123], v6 offset:22528
    s_waitcnt lgkmcnt(14)
    v_mfma_f32_32x32x16_bf16 v[80:95], v[156:159], v[172:175], v[80:95]
    ds_read_b64_tr_b16 v[124:125], v7 offset:18432
    ds_read_b64_tr_b16 v[126:127], v7 offset:22528
    s_waitcnt vmcnt(12)
    s_waitcnt lgkmcnt(14)
    v_mfma_f32_32x32x16_bf16 v[32:47], v[96:99], v[176:179], v[32:47]
    buffer_load_dwordx4 v[168:171], v16, s[32:35], s66 offen sc1
    s_waitcnt lgkmcnt(12)
    v_mfma_f32_32x32x16_bf16 v[48:63], v[100:103], v[176:179], v[48:63]
    ds_read_b64_tr_b16 v[128:129], v4 offset:24576
    ds_read_b64_tr_b16 v[130:131], v4 offset:28672
    ds_read_b64_tr_b16 v[132:133], v5 offset:24576
    s_waitcnt lgkmcnt(13)
    v_mfma_f32_32x32x16_bf16 v[64:79], v[104:107], v[176:179], v[64:79]
    ds_read_b64_tr_b16 v[134:135], v5 offset:28672
    ds_read_b64_tr_b16 v[136:137], v6 offset:24576
    ds_read_b64_tr_b16 v[138:139], v6 offset:28672
    s_waitcnt lgkmcnt(14)
    v_mfma_f32_32x32x16_bf16 v[80:95], v[108:111], v[176:179], v[80:95]
    ds_read_b64_tr_b16 v[140:141], v7 offset:24576
    ds_read_b64_tr_b16 v[142:143], v7 offset:28672
    s_waitcnt lgkmcnt(14)
    v_mfma_f32_32x32x16_bf16 v[32:47], v[112:115], v[180:183], v[32:47]
    buffer_load_dwordx4 v[172:175], v16, s[32:35], s66 offen offset:512 sc1
    s_add_u32 s45, s45, 1
    v_readlane_b32 s66, v25, s45
    s_waitcnt lgkmcnt(12)
    v_mfma_f32_32x32x16_bf16 v[48:63], v[116:119], v[180:183], v[48:63]
    ds_read_b64_tr_b16 v[144:145], v4 offset:26624
    ds_read_b64_tr_b16 v[146:147], v4 offset:30720
    ds_read_b64_tr_b16 v[148:149], v5 offset:26624
    s_waitcnt lgkmcnt(13)
    v_mfma_f32_32x32x16_bf16 v[64:79], v[120:123], v[180:183], v[64:79]
    ds_read_b64_tr_b16 v[150:151], v5 offset:30720
    ds_read_b64_tr_b16 v[152:153], v6 offset:26624
    ds_read_b64_tr_b16 v[154:155], v6 offset:30720
    s_waitcnt lgkmcnt(14)
    v_mfma_f32_32x32x16_bf16 v[80:95], v[124:127], v[180:183], v[80:95]
    ds_read_b64_tr_b16 v[156:157], v7 offset:26624
    ds_read_b64_tr_b16 v[158:159], v7 offset:30720
    s_waitcnt vmcnt(12)
    s_waitcnt lgkmcnt(14)
    v_mfma_f32_32x32x16_bf16 v[32:47], v[128:131], v[184:187], v[32:47]
    buffer_load_dwordx4 v[176:179], v16, s[32:35], s66 offen sc1
    s_barrier
    s_waitcnt lgkmcnt(12)
    v_mfma_f32_32x32x16_bf16 v[48:63], v[132:135], v[184:187], v[48:63]
    ds_read_b64_tr_b16 v[96:97], v4 offset:32768
    ds_read_b64_tr_b16 v[98:99], v4 offset:36864
    ds_read_b64_tr_b16 v[100:101], v5 offset:32768
    s_waitcnt lgkmcnt(13)
    v_mfma_f32_32x32x16_bf16 v[64:79], v[136:139], v[184:187], v[64:79]
    ds_read_b64_tr_b16 v[102:103], v5 offset:36864
    ds_read_b64_tr_b16 v[104:105], v6 offset:32768
    ds_read_b64_tr_b16 v[106:107], v6 offset:36864
    s_waitcnt lgkmcnt(14)
    v_mfma_f32_32x32x16_bf16 v[80:95], v[140:143], v[184:187], v[80:95]
    ds_read_b64_tr_b16 v[108:109], v7 offset:32768
    ds_read_b64_tr_b16 v[110:111], v7 offset:36864
    s_waitcnt lgkmcnt(14)
    v_mfma_f32_32x32x16_bf16 v[32:47], v[144:147], v[188:191], v[32:47]
    buffer_load_dwordx4 v[180:183], v16, s[32:35], s66 offen offset:512 sc1
    s_add_u32 s45, s45, 1
    v_readlane_b32 s66, v25, s45
    s_waitcnt lgkmcnt(12)
    v_mfma_f32_32x32x16_bf16 v[48:63], v[148:151], v[188:191], v[48:63]
    ds_read_b64_tr_b16 v[112:113], v4 offset:34816
    ds_read_b64_tr_b16 v[114:115], v4 offset:38912
    ds_read_b64_tr_b16 v[116:117], v5 offset:34816
    s_waitcnt lgkmcnt(13)
    v_mfma_f32_32x32x16_bf16 v[64:79], v[152:155], v[188:191], v[64:79]
    ds_read_b64_tr_b16 v[118:119], v5 offset:38912
    ds_read_b64_tr_b16 v[120:121], v6 offset:34816
    ds_read_b64_tr_b16 v[122:123], v6 offset:38912
    s_waitcnt lgkmcnt(14)
    v_mfma_f32_32x32x16_bf16 v[80:95], v[156:159], v[188:191], v[80:95]
    ds_read_b64_tr_b16 v[124:125], v7 offset:34816
    ds_read_b64_tr_b16 v[126:127], v7 offset:38912
    s_waitcnt vmcnt(12)
    s_waitcnt lgkmcnt(14)
    v_mfma_f32_32x32x16_bf16 v[32:47], v[96:99], v[192:195], v[32:47]
    buffer_load_dwordx4 v[184:187], v16, s[32:35], s66 offen sc1
    s_waitcnt lgkmcnt(12)
    v_mfma_f32_32x32x16_bf16 v[48:63], v[100:103], v[192:195], v[48:63]
    ds_read_b64_tr_b16 v[128:129], v4 offset:40960
    ds_read_b64_tr_b16 v[130:131], v4 offset:45056
    ds_read_b64_tr_b16 v[132:133], v5 offset:40960
    s_waitcnt lgkmcnt(13)
    v_mfma_f32_32x32x16_bf16 v[64:79], v[104:107], v[192:195], v[64:79]
    ds_read_b64_tr_b16 v[134:135], v5 offset:45056
    ds_read_b64_tr_b16 v[136:137], v6 offset:40960
    ds_read_b64_tr_b16 v[138:139], v6 offset:45056
    s_waitcnt lgkmcnt(14)
    v_mfma_f32_32x32x16_bf16 v[80:95], v[108:111], v[192:195], v[80:95]
    ds_read_b64_tr_b16 v[140:141], v7 offset:40960
    ds_read_b64_tr_b16 v[142:143], v7 offset:45056
    s_waitcnt lgkmcnt(14)
    v_mfma_f32_32x32x16_bf16 v[32:47], v[112:115], v[196:199], v[32:47]
    buffer_load_dwordx4 v[188:191], v16, s[32:35], s66 offen offset:512 sc1
    s_add_u32 s45, s45, 1
    v_readlane_b32 s66, v25, s45
    s_waitcnt lgkmcnt(12)
    v_mfma_f32_32x32x16_bf16 v[48:63], v[116:119], v[196:199], v[48:63]
    ds_read_b64_tr_b16 v[144:145], v4 offset:43008
    ds_read_b64_tr_b16 v[146:147], v4 offset:47104
    ds_read_b64_tr_b16 v[148:149], v5 offset:43008
    s_waitcnt lgkmcnt(13)
    v_mfma_f32_32x32x16_bf16 v[64:79], v[120:123], v[196:199], v[64:79]
    ds_read_b64_tr_b16 v[150:151], v5 offset:47104
    ds_read_b64_tr_b16 v[152:153], v6 offset:43008
    ds_read_b64_tr_b16 v[154:155], v6 offset:47104
    s_waitcnt lgkmcnt(14)
    v_mfma_f32_32x32x16_bf16 v[80:95], v[124:127], v[196:199], v[80:95]
    ds_read_b64_tr_b16 v[156:157], v7 offset:43008
    ds_read_b64_tr_b16 v[158:159], v7 offset:47104
    s_waitcnt vmcnt(12)
    s_waitcnt lgkmcnt(14)
    v_mfma_f32_32x32x16_bf16 v[32:47], v[128:131], v[200:203], v[32:47]
    buffer_load_dwordx4 v[192:195], v16, s[32:35], s66 offen sc1
    s_barrier
    s_waitcnt lgkmcnt(12)
    v_mfma_f32_32x32x16_bf16 v[48:63], v[132:135], v[200:203], v[48:63]
    ds_read_b64_tr_b16 v[96:97], v4 offset:49152
    ds_read_b64_tr_b16 v[98:99], v4 offset:53248
    ds_read_b64_tr_b16 v[100:101], v5 offset:49152
    s_waitcnt lgkmcnt(13)
    v_mfma_f32_32x32x16_bf16 v[64:79], v[136:139], v[200:203], v[64:79]
    ds_read_b64_tr_b16 v[102:103], v5 offset:53248
    ds_read_b64_tr_b16 v[104:105], v6 offset:49152
    ds_read_b64_tr_b16 v[106:107], v6 offset:53248
    s_waitcnt lgkmcnt(14)
    v_mfma_f32_32x32x16_bf16 v[80:95], v[140:143], v[200:203], v[80:95]
    ds_read_b64_tr_b16 v[108:109], v7 offset:49152
    ds_read_b64_tr_b16 v[110:111], v7 offset:53248
    s_waitcnt lgkmcnt(14)
    v_mfma_f32_32x32x16_bf16 v[32:47], v[144:147], v[204:207], v[32:47]
    buffer_load_dwordx4 v[196:199], v16, s[32:35], s66 offen offset:512 sc1
    s_add_u32 s45, s45, 1
    v_readlane_b32 s66, v25, s45
    s_waitcnt lgkmcnt(12)
    v_mfma_f32_32x32x16_bf16 v[48:63], v[148:151], v[204:207], v[48:63]
    ds_read_b64_tr_b16 v[112:113], v4 offset:51200
    ds_read_b64_tr_b16 v[114:115], v4 offset:55296
    ds_read_b64_tr_b16 v[116:117], v5 offset:51200
    s_waitcnt lgkmcnt(13)
    v_mfma_f32_32x32x16_bf16 v[64:79], v[152:155], v[204:207], v[64:79]
    ds_read_b64_tr_b16 v[118:119], v5 offset:55296
    ds_read_b64_tr_b16 v[120:121], v6 offset:51200
    ds_read_b64_tr_b16 v[122:123], v6 offset:55296
    s_waitcnt lgkmcnt(14)
    v_mfma_f32_32x32x16_bf16 v[80:95], v[156:159], v[204:207], v[80:95]
    ds_read_b64_tr_b16 v[124:125], v7 offset:51200
    ds_read_b64_tr_b16 v[126:127], v7 offset:55296
    s_waitcnt vmcnt(12)
    s_waitcnt lgkmcnt(14)
    v_mfma_f32_32x32x16_bf16 v[32:47], v[96:99], v[208:211], v[32:47]
    buffer_load_dwordx4 v[200:203], v16, s[32:35], s66 offen sc1
    s_waitcnt lgkmcnt(12)
    v_mfma_f32_32x32x16_bf16 v[48:63], v[100:103], v[208:211], v[48:63]
    ds_read_b64_tr_b16 v[128:129], v4 offset:57344
    ds_read_b64_tr_b16 v[130:131], v4 offset:61440
    ds_read_b64_tr_b16 v[132:133], v5 offset:57344
    s_waitcnt lgkmcnt(13)
    v_mfma_f32_32x32x16_bf16 v[64:79], v[104:107], v[208:211], v[64:79]
    ds_read_b64_tr_b16 v[134:135], v5 offset:61440
    ds_read_b64_tr_b16 v[136:137], v6 offset:57344
    ds_read_b64_tr_b16 v[138:139], v6 offset:61440
    s_waitcnt lgkmcnt(14)
    v_mfma_f32_32x32x16_bf16 v[80:95], v[108:111], v[208:211], v[80:95]
    ds_read_b64_tr_b16 v[140:141], v7 offset:57344
    ds_read_b64_tr_b16 v[142:143], v7 offset:61440
    s_waitcnt lgkmcnt(14)
    v_mfma_f32_32x32x16_bf16 v[32:47], v[112:115], v[212:215], v[32:47]
    buffer_load_dwordx4 v[204:207], v16, s[32:35], s66 offen offset:512 sc1
    s_add_u32 s45, s45, 1
    v_readlane_b32 s66, v25, s45
    s_waitcnt lgkmcnt(12)
    v_mfma_f32_32x32x16_bf16 v[48:63], v[116:119], v[212:215], v[48:63]
    ds_read_b64_tr_b16 v[144:145], v4 offset:59392
    ds_read_b64_tr_b16 v[146:147], v4 offset:63488
    ds_read_b64_tr_b16 v[148:149], v5 offset:59392
    s_waitcnt lgkmcnt(13)
    v_mfma_f32_32x32x16_bf16 v[64:79], v[120:123], v[212:215], v[64:79]
    ds_read_b64_tr_b16 v[150:151], v5 offset:63488
    ds_read_b64_tr_b16 v[152:153], v6 offset:59392
    ds_read_b64_tr_b16 v[154:155], v6 offset:63488
    s_waitcnt lgkmcnt(14)
    v_mfma_f32_32x32x16_bf16 v[80:95], v[124:127], v[212:215], v[80:95]
    ds_read_b64_tr_b16 v[156:157], v7 offset:59392
    ds_read_b64_tr_b16 v[158:159], v7 offset:63488
    s_waitcnt vmcnt(12)
    s_waitcnt lgkmcnt(14)
    v_mfma_f32_32x32x16_bf16 v[32:47], v[128:131], v[216:219], v[32:47]
    buffer_load_dwordx4 v[208:211], v16, s[32:35], s66 offen sc1
    s_barrier
    s_waitcnt lgkmcnt(12)
    v_mfma_f32_32x32x16_bf16 v[48:63], v[132:135], v[216:219], v[48:63]
    v_xor_b32 v4, 0x10000, v4
    ds_read_b64_tr_b16 v[96:97], v4 offset:0
    ds_read_b64_tr_b16 v[98:99], v4 offset:4096
    v_xor_b32 v5, 0x10000, v5
    ds_read_b64_tr_b16 v[100:101], v5 offset:0
    s_waitcnt lgkmcnt(13)
    v_mfma_f32_32x32x16_bf16 v[64:79], v[136:139], v[216:219], v[64:79]
    ds_read_b64_tr_b16 v[102:103], v5 offset:4096
    v_xor_b32 v6, 0x10000, v6
    ds_read_b64_tr_b16 v[104:105], v6 offset:0
    ds_read_b64_tr_b16 v[106:107], v6 offset:4096
    s_waitcnt lgkmcnt(14)
    v_mfma_f32_32x32x16_bf16 v[80:95], v[140:143], v[216:219], v[80:95]
    v_xor_b32 v7, 0x10000, v7
    ds_read_b64_tr_b16 v[108:109], v7 offset:0
    ds_read_b64_tr_b16 v[110:111], v7 offset:4096
    s_waitcnt lgkmcnt(14)
    v_mfma_f32_32x32x16_bf16 v[32:47], v[144:147], v[220:223], v[32:47]
    buffer_load_dwordx4 v[212:215], v16, s[32:35], s66 offen offset:512 sc1
    s_add_u32 s45, s45, 1
    v_readlane_b32 s66, v25, s45
    s_waitcnt lgkmcnt(12)
    v_mfma_f32_32x32x16_bf16 v[48:63], v[148:151], v[220:223], v[48:63]
    ds_read_b64_tr_b16 v[112:113], v4 offset:2048
    ds_read_b64_tr_b16 v[114:115], v4 offset:6144
    ds_read_b64_tr_b16 v[116:117], v5 offset:2048
    s_waitcnt lgkmcnt(13)
    v_mfma_f32_32x32x16_bf16 v[64:79], v[152:155], v[220:223], v[64:79]
    ds_read_b64_tr_b16 v[118:119], v5 offset:6144
    ds_read_b64_tr_b16 v[120:121], v6 offset:2048
    ds_read_b64_tr_b16 v[122:123], v6 offset:6144
    s_waitcnt lgkmcnt(14)
    v_mfma_f32_32x32x16_bf16 v[80:95], v[156:159], v[220:223], v[80:95]
    ds_read_b64_tr_b16 v[124:125], v7 offset:2048
    ds_read_b64_tr_b16 v[126:127], v7 offset:6144
    s_add_u32 s60, s60, 1
    s_cmp_lt_u32 s60, 5
    s_cbranch_scc1 L_LOOP2
    v_lshlrev_b32 v15, 4, v2
    s_lshl_b32 s46, s62, 13
    s_add_u32 s46, s46, 33554432
    s_add_u32 s47, s46, 4096
    s_xor_b32 s48, s46, 262144
    s_add_u32 s49, s48, 4096
    s_xor_b32 s50, s63, 8192
    v_mov_b32 v3, 0
    v_mov_b32 v18, 1
    s_waitcnt vmcnt(12)
    s_waitcnt lgkmcnt(14)
    v_mfma_f32_32x32x16_bf16 v[32:47], v[96:99], v[160:163], v[32:47]
    buffer_load_dwordx4 v[216:219], v16, s[32:35], s66 offen sc1
    s_waitcnt lgkmcnt(12)
    v_mfma_f32_32x32x16_bf16 v[48:63], v[100:103], v[160:163], v[48:63]
    ds_read_b64_tr_b16 v[128:129], v6 offset:8192
    ds_read_b64_tr_b16 v[130:131], v6 offset:12288
    ds_read_b64_tr_b16 v[132:133], v7 offset:8192
    s_waitcnt lgkmcnt(13)
    v_mfma_f32_32x32x16_bf16 v[64:79], v[104:107], v[160:163], v[64:79]
    ds_read_b64_tr_b16 v[134:135], v7 offset:12288
    ds_read_b64_tr_b16 v[136:137], v6 offset:10240
    ds_read_b64_tr_b16 v[138:139], v6 offset:14336
    s_waitcnt lgkmcnt(14)
    v_mfma_f32_32x32x16_bf16 v[80:95], v[108:111], v[160:163], v[80:95]
    ds_read_b64_tr_b16 v[140:141], v7 offset:10240
    ds_read_b64_tr_b16 v[142:143], v7 offset:14336
    s_waitcnt lgkmcnt(14)
    v_mfma_f32_32x32x16_bf16 v[32:47], v[112:115], v[164:167], v[32:47]
    buffer_load_dwordx4 v[220:223], v16, s[32:35], s66 offen offset:512 sc1
    s_barrier
    s_waitcnt lgkmcnt(12)
    v_mfma_f32_32x32x16_bf16 v[48:63], v[116:119], v[164:167], v[48:63]
    ds_read_b64_tr_b16 v[144:145], v6 offset:16384
    ds_read_b64_tr_b16 v[146:147], v6 offset:20480
    ds_read_b64_tr_b16 v[148:149], v7 offset:16384
    s_waitcnt lgkmcnt(13)
    v_mfma_f32_32x32x16_bf16 v[64:79], v[120:123], v[164:167], v[64:79]
    ds_read_b64_tr_b16 v[150:151], v7 offset:20480
    ds_read_b64_tr_b16 v[152:153], v6 offset:18432
    ds_read_b64_tr_b16 v[154:155], v6 offset:22528
    s_waitcnt lgkmcnt(14)
    v_mfma_f32_32x32x16_bf16 v[80:95], v[124:127], v[164:167], v[80:95]
    ds_read_b64_tr_b16 v[156:157], v7 offset:18432
    ds_read_b64_tr_b16 v[158:159], v7 offset:22528
    s_waitcnt vmcnt(12)
    s_waitcnt lgkmcnt(14)
    v_mfma_f32_32x32x16_bf16 v[64:79], v[128:131], v[168:171], v[64:79]
    s_waitcnt lgkmcnt(12)
    v_mfma_f32_32x32x16_bf16 v[80:95], v[132:135], v[168:171], v[80:95]
    ds_read_b64_tr_b16 v[96:97], v6 offset:24576
    ds_read_b64_tr_b16 v[98:99], v6 offset:28672
    ds_read_b64_tr_b16 v[100:101], v7 offset:24576
    s_waitcnt lgkmcnt(13)
    v_mfma_f32_32x32x16_bf16 v[64:79], v[136:139], v[172:175], v[64:79]
    ds_read_b64_tr_b16 v[102:103], v7 offset:28672
    ds_read_b64_tr_b16 v[104:105], v6 offset:26624
    ds_read_b64_tr_b16 v[106:107], v6 offset:30720
    s_waitcnt lgkmcnt(14)
    v_mfma_f32_32x32x16_bf16 v[80:95], v[140:143], v[172:175], v[80:95]
    ds_read_b64_tr_b16 v[108:109], v7 offset:26624
    ds_read_b64_tr_b16 v[110:111], v7 offset:30720
    s_waitcnt vmcnt(10)
    s_waitcnt lgkmcnt(14)
    v_mfma_f32_32x32x16_bf16 v[64:79], v[144:147], v[176:179], v[64:79]
    s_barrier
    s_waitcnt lgkmcnt(12)
    v_mfma_f32_32x32x16_bf16 v[80:95], v[148:151], v[176:179], v[80:95]
    ds_read_b64_tr_b16 v[112:113], v6 offset:32768
    ds_read_b64_tr_b16 v[114:115], v6 offset:36864
    ds_read_b64_tr_b16 v[116:117], v7 offset:32768
    s_waitcnt lgkmcnt(13)
    v_mfma_f32_32x32x16_bf16 v[64:79], v[152:155], v[180:183], v[64:79]
    ds_read_b64_tr_b16 v[118:119], v7 offset:36864
    ds_read_b64_tr_b16 v[120:121], v6 offset:34816
    ds_read_b64_tr_b16 v[122:123], v6 offset:38912
    s_waitcnt lgkmcnt(14)
    v_mfma_f32_32x32x16_bf16 v[80:95], v[156:159], v[180:183], v[80:95]
    ds_read_b64_tr_b16 v[124:125], v7 offset:34816
    ds_read_b64_tr_b16 v[126:127], v7 offset:38912
    s_waitcnt vmcnt(8)
    s_waitcnt lgkmcnt(14)
    v_mfma_f32_32x32x16_bf16 v[64:79], v[96:99], v[184:187], v[64:79]
    s_waitcnt lgkmcnt(12)
    v_mfma_f32_32x32x16_bf16 v[80:95], v[100:103], v[184:187], v[80:95]
    ds_read_b64_tr_b16 v[128:129], v6 offset:40960
    ds_read_b64_tr_b16 v[130:131], v6 offset:45056
    ds_read_b64_tr_b16 v[132:133], v7 offset:40960
    s_waitcnt lgkmcnt(13)
    v_mfma_f32_32x32x16_bf16 v[64:79], v[104:107], v[188:191], v[64:79]
    ds_read_b64_tr_b16 v[134:135], v7 offset:45056
    ds_read_b64_tr_b16 v[136:137], v6 offset:43008
    ds_read_b64_tr_b16 v[138:139], v6 offset:47104
    s_waitcnt lgkmcnt(14)
    v_mfma_f32_32x32x16_bf16 v[80:95], v[108:111], v[188:191], v[80:95]
    ds_read_b64_tr_b16 v[140:141], v7 offset:43008
    ds_read_b64_tr_b16 v[142:143], v7 offset:47104
    s_waitcnt vmcnt(6)
    s_waitcnt lgkmcnt(14)
    v_mfma_f32_32x32x16_bf16 v[64:79], v[112:115], v[192:195], v[64:79]
    s_barrier
    s_waitcnt lgkmcnt(12)
    v_mfma_f32_32x32x16_bf16 v[80:95], v[116:119], v[192:195], v[80:95]
    ds_read_b64_tr_b16 v[144:145], v6 offset:49152
    ds_read_b64_tr_b16 v[146:147], v6 offset:53248
    ds_read_b64_tr_b16 v[148:149], v7 offset:49152
    s_waitcnt lgkmcnt(13)
    v_mfma_f32_32x32x16_bf16 v[64:79], v[120:123], v[196:199], v[64:79]
    ds_read_b64_tr_b16 v[150:151], v7 offset:53248
    ds_read_b64_tr_b16 v[152:153], v6 offset:51200
    ds_read_b64_tr_b16 v[154:155], v6 offset:55296
    s_waitcnt lgkmcnt(14)
    v_mfma_f32_32x32x16_bf16 v[80:95], v[124:127], v[196:199], v[80:95]
    ds_read_b64_tr_b16 v[156:157], v7 offset:51200
    ds_read_b64_tr_b16 v[158:159], v7 offset:55296
    s_waitcnt vmcnt(4)
    s_waitcnt lgkmcnt(14)
    v_mfma_f32_32x32x16_bf16 v[64:79], v[128:131], v[200:203], v[64:79]
    s_waitcnt lgkmcnt(12)
    v_mfma_f32_32x32x16_bf16 v[80:95], v[132:135], v[200:203], v[80:95]
    ds_read_b64_tr_b16 v[96:97], v6 offset:57344
    ds_read_b64_tr_b16 v[98:99], v6 offset:61440
    ds_read_b64_tr_b16 v[100:101], v7 offset:57344
    s_waitcnt lgkmcnt(13)
    v_mfma_f32_32x32x16_bf16 v[64:79], v[136:139], v[204:207], v[64:79]
    ds_read_b64_tr_b16 v[102:103], v7 offset:61440
    ds_read_b64_tr_b16 v[104:105], v6 offset:59392
    ds_read_b64_tr_b16 v[106:107], v6 offset:63488
    s_waitcnt lgkmcnt(14)
    v_mfma_f32_32x32x16_bf16 v[80:95], v[140:143], v[204:207], v[80:95]
    ds_read_b64_tr_b16 v[108:109], v7 offset:59392
    ds_read_b64_tr_b16 v[110:111], v7 offset:63488
    s_waitcnt vmcnt(2)
    s_waitcnt lgkmcnt(14)
    v_mfma_f32_32x32x16_bf16 v[64:79], v[144:147], v[208:211], v[64:79]
    s_waitcnt lgkmcnt(12)
    v_mfma_f32_32x32x16_bf16 v[80:95], v[148:151], v[208:211], v[80:95]
    ds_read_b64_tr_b16 v[112:113], v4 offset:8192
    ds_read_b64_tr_b16 v[114:115], v4 offset:12288
    ds_read_b64_tr_b16 v[116:117], v5 offset:8192
    s_waitcnt lgkmcnt(13)
    v_mfma_f32_32x32x16_bf16 v[64:79], v[152:155], v[212:215], v[64:79]
    ds_read_b64_tr_b16 v[118:119], v5 offset:12288
    ds_read_b64_tr_b16 v[120:121], v4 offset:10240
    ds_read_b64_tr_b16 v[122:123], v4 offset:14336
    s_waitcnt lgkmcnt(14)
    v_mfma_f32_32x32x16_bf16 v[80:95], v[156:159], v[212:215], v[80:95]
    ds_read_b64_tr_b16 v[124:125], v5 offset:10240
    ds_read_b64_tr_b16 v[126:127], v5 offset:14336
    s_waitcnt vmcnt(0)
    s_waitcnt lgkmcnt(14)
    v_mfma_f32_32x32x16_bf16 v[64:79], v[96:99], v[216:219], v[64:79]
    s_waitcnt lgkmcnt(12)
    v_mfma_f32_32x32x16_bf16 v[80:95], v[100:103], v[216:219], v[80:95]
    ds_read_b64_tr_b16 v[128:129], v4 offset:16384
    ds_read_b64_tr_b16 v[130:131], v4 offset:20480
    ds_read_b64_tr_b16 v[132:133], v5 offset:16384
    s_waitcnt lgkmcnt(13)
    v_mfma_f32_32x32x16_bf16 v[64:79], v[104:107], v[220:223], v[64:79]
    ds_read_b64_tr_b16 v[134:135], v5 offset:20480
    ds_read_b64_tr_b16 v[136:137], v4 offset:18432
    ds_read_b64_tr_b16 v[138:139], v4 offset:22528
    s_waitcnt lgkmcnt(14)
    v_mfma_f32_32x32x16_bf16 v[80:95], v[108:111], v[220:223], v[80:95]
    ds_read_b64_tr_b16 v[140:141], v5 offset:18432
    ds_read_b64_tr_b16 v[142:143], v5 offset:22528
    s_waitcnt lgkmcnt(14)
    v_mfma_f32_32x32x16_bf16 v[32:47], v[112:115], v[168:171], v[32:47]
    s_waitcnt lgkmcnt(12)
    v_mfma_f32_32x32x16_bf16 v[48:63], v[116:119], v[168:171], v[48:63]
    ds_read_b64_tr_b16 v[144:145], v4 offset:24576
    ds_read_b64_tr_b16 v[146:147], v4 offset:28672
    ds_read_b64_tr_b16 v[148:149], v5 offset:24576
    s_waitcnt lgkmcnt(13)
    v_mfma_f32_32x32x16_bf16 v[32:47], v[120:123], v[172:175], v[32:47]
    s_nop 3
    buffer_store_dwordx4 v[64:67], v15, s[32:35], s46 offen offset:0 sc1
    ds_read_b64_tr_b16 v[150:151], v5 offset:28672
    ds_read_b64_tr_b16 v[152:153], v4 offset:26624
    ds_read_b64_tr_b16 v[154:155], v4 offset:30720
    s_waitcnt lgkmcnt(14)
    v_mfma_f32_32x32x16_bf16 v[48:63], v[124:127], v[172:175], v[48:63]
    buffer_store_dwordx4 v[68:71], v15, s[32:35], s46 offen offset:1024 sc1
    ds_read_b64_tr_b16 v[156:157], v5 offset:26624
    ds_read_b64_tr_b16 v[158:159], v5 offset:30720
    s_waitcnt lgkmcnt(14)
    v_mfma_f32_32x32x16_bf16 v[32:47], v[128:131], v[176:179], v[32:47]
    buffer_store_dwordx4 v[72:75], v15, s[32:35], s46 offen offset:2048 sc1
    buffer_store_dwordx4 v[76:79], v15, s[32:35], s46 offen offset:3072 sc1
    s_waitcnt lgkmcnt(12)
    v_mfma_f32_32x32x16_bf16 v[48:63], v[132:135], v[176:179], v[48:63]
    buffer_store_dwordx4 v[80:83], v15, s[32:35], s47 offen offset:0 sc1
    ds_read_b64_tr_b16 v[96:97], v4 offset:32768
    ds_read_b64_tr_b16 v[98:99], v4 offset:36864
    ds_read_b64_tr_b16 v[100:101], v5 offset:32768
    s_waitcnt lgkmcnt(13)
    v_mfma_f32_32x32x16_bf16 v[32:47], v[136:139], v[180:183], v[32:47]
    buffer_store_dwordx4 v[84:87], v15, s[32:35], s47 offen offset:1024 sc1
    ds_read_b64_tr_b16 v[102:103], v5 offset:36864
    ds_read_b64_tr_b16 v[104:105], v4 offset:34816
    ds_read_b64_tr_b16 v[106:107], v4 offset:38912
    s_waitcnt lgkmcnt(14)
    v_mfma_f32_32x32x16_bf16 v[48:63], v[140:143], v[180:183], v[48:63]
    buffer_store_dwordx4 v[88:91], v15, s[32:35], s47 offen offset:2048 sc1
    ds_read_b64_tr_b16 v[108:109], v5 offset:34816
    ds_read_b64_tr_b16 v[110:111], v5 offset:38912
    s_waitcnt lgkmcnt(14)
    v_mfma_f32_32x32x16_bf16 v[32:47], v[144:147], v[184:187], v[32:47]
    buffer_store_dwordx4 v[92:95], v15, s[32:35], s47 offen offset:3072 sc1
    s_waitcnt lgkmcnt(12)
    v_mfma_f32_32x32x16_bf16 v[48:63], v[148:151], v[184:187], v[48:63]
    ds_read_b64_tr_b16 v[112:113], v4 offset:40960
    ds_read_b64_tr_b16 v[114:115], v4 offset:45056
    ds_read_b64_tr_b16 v[116:117], v5 offset:40960
    s_waitcnt lgkmcnt(13)
    v_mfma_f32_32x32x16_bf16 v[32:47], v[152:155], v[188:191], v[32:47]
    ds_read_b64_tr_b16 v[118:119], v5 offset:45056
    ds_read_b64_tr_b16 v[120:121], v4 offset:43008
    ds_read_b64_tr_b16 v[122:123], v4 offset:47104
    s_waitcnt lgkmcnt(14)
    v_mfma_f32_32x32x16_bf16 v[48:63], v[156:159], v[188:191], v[48:63]
    ds_read_b64_tr_b16 v[124:125], v5 offset:43008
    ds_read_b64_tr_b16 v[126:127], v5 offset:47104
    s_waitcnt lgkmcnt(14)
    v_mfma_f32_32x32x16_bf16 v[32:47], v[96:99], v[192:195], v[32:47]
    s_waitcnt lgkmcnt(12)
    v_mfma_f32_32x32x16_bf16 v[48:63], v[100:103], v[192:195], v[48:63]
    ds_read_b64_tr_b16 v[128:129], v4 offset:49152
    ds_read_b64_tr_b16 v[130:131], v4 offset:53248
    ds_read_b64_tr_b16 v[132:133], v5 offset:49152
    s_waitcnt lgkmcnt(13)
    v_mfma_f32_32x32x16_bf16 v[32:47], v[104:107], v[196:199], v[32:47]
    ds_read_b64_tr_b16 v[134:135], v5 offset:53248
    ds_read_b64_tr_b16 v[136:137], v4 offset:51200
    ds_read_b64_tr_b16 v[138:139], v4 offset:55296
    s_waitcnt lgkmcnt(14)
    v_mfma_f32_32x32x16_bf16 v[48:63], v[108:111], v[196:199], v[48:63]
    ds_read_b64_tr_b16 v[140:141], v5 offset:51200
    ds_read_b64_tr_b16 v[142:143], v5 offset:55296
    s_waitcnt lgkmcnt(14)
    v_mfma_f32_32x32x16_bf16 v[32:47], v[112:115], v[200:203], v[32:47]
    s_waitcnt lgkmcnt(12)
    v_mfma_f32_32x32x16_bf16 v[48:63], v[116:119], v[200:203], v[48:63]
    ds_read_b64_tr_b16 v[144:145], v4 offset:57344
    ds_read_b64_tr_b16 v[146:147], v4 offset:61440
    ds_read_b64_tr_b16 v[148:149], v5 offset:57344
    s_waitcnt lgkmcnt(13)
    v_mfma_f32_32x32x16_bf16 v[32:47], v[120:123], v[204:207], v[32:47]
    ds_read_b64_tr_b16 v[150:151], v5 offset:61440
    ds_read_b64_tr_b16 v[152:153], v4 offset:59392
    ds_read_b64_tr_b16 v[154:155], v4 offset:63488
    s_waitcnt lgkmcnt(14)
    v_mfma_f32_32x32x16_bf16 v[48:63], v[124:127], v[204:207], v[48:63]
    ds_read_b64_tr_b16 v[156:157], v5 offset:59392
    ds_read_b64_tr_b16 v[158:159], v5 offset:63488
    s_waitcnt vmcnt(0)
    buffer_store_dword v18, v3, s[32:35], s50 offen sc1
    s_waitcnt lgkmcnt(14)
    v_mfma_f32_32x32x16_bf16 v[32:47], v[128:131], v[208:211], v[32:47]
    s_waitcnt lgkmcnt(12)
    v_mfma_f32_32x32x16_bf16 v[48:63], v[132:135], v[208:211], v[48:63]
    s_waitcnt lgkmcnt(10)
    v_mfma_f32_32x32x16_bf16 v[32:47], v[136:139], v[212:215], v[32:47]
    s_waitcnt lgkmcnt(8)
    v_mfma_f32_32x32x16_bf16 v[48:63], v[140:143], v[212:215], v[48:63]
    s_waitcnt lgkmcnt(6)
    v_mfma_f32_32x32x16_bf16 v[32:47], v[144:147], v[216:219], v[32:47]
    s_waitcnt lgkmcnt(4)
    v_mfma_f32_32x32x16_bf16 v[48:63], v[148:151], v[216:219], v[48:63]
    s_waitcnt lgkmcnt(2)
    v_mfma_f32_32x32x16_bf16 v[32:47], v[152:155], v[220:223], v[32:47]
    s_waitcnt lgkmcnt(0)
    v_mfma_f32_32x32x16_bf16 v[48:63], v[156:159], v[220:223], v[48:63]
    s_lshl_b32 s42, s20, 7
    s_lshl_b32 s43, s3, 5
    s_add_u32 s42, s42, s43
    s_lshl_b32 s42, s42, 11
    s_add_u32 s42, s42, s54
    v_and_b32 v16, 31, v2
    v_lshlrev_b32 v16, 11, v16
    v_lshl_add_u32 v16, v17, 4, v16
    s_mov_b32 s51, 40000
L_XPOLL:
    buffer_load_dword v19, v3, s[32:35], s63 offen sc1
    s_sub_u32 s51, s51, 1
    s_waitcnt vmcnt(0)
    v_readfirstlane_b32 s52, v19
    s_cmp_eq_u32 s52, 1
    s_cbranch_scc1 L_XDONE
    s_cmp_lg_u32 s51, 0
    s_cbranch_scc1 L_XPOLL
L_XDONE:
    buffer_load_dwordx4 v[160:163], v15, s[32:35], s48 offen offset:0 sc1
    buffer_load_dwordx4 v[164:167], v15, s[32:35], s48 offen offset:1024 sc1
    buffer_load_dwordx4 v[168:171], v15, s[32:35], s48 offen offset:2048 sc1
    buffer_load_dwordx4 v[172:175], v15, s[32:35], s48 offen offset:3072 sc1
    buffer_load_dwordx4 v[176:179], v15, s[32:35], s49 offen offset:0 sc1
    buffer_load_dwordx4 v[180:183], v15, s[32:35], s49 offen offset:1024 sc1
    buffer_load_dwordx4 v[184:187], v15, s[32:35], s49 offen offset:2048 sc1
    buffer_load_dwordx4 v[188:191], v15, s[32:35], s49 offen offset:3072 sc1
    s_waitcnt vmcnt(6)
    v_pk_add_f32 v[32:33], v[32:33], v[160:161]
    v_pk_add_f32 v[34:35], v[34:35], v[162:163]
    v_pk_add_f32 v[36:37], v[36:37], v[164:165]
    v_pk_add_f32 v[38:39], v[38:39], v[166:167]
    v_cvt_pk_bf16_f32 v160, v32, v33
    v_cvt_pk_bf16_f32 v161, v34, v35
    v_cvt_pk_bf16_f32 v162, v36, v37
    v_cvt_pk_bf16_f32 v163, v38, v39
    s_nop 1
    v_permlane32_swap_b32 v160, v162
    v_permlane32_swap_b32 v161, v163
    buffer_store_dwordx4 v[160:163], v16, s[36:39], s42 offen offset:0
    s_waitcnt vmcnt(5)
    v_pk_add_f32 v[40:41], v[40:41], v[168:169]
    v_pk_add_f32 v[42:43], v[42:43], v[170:171]
    v_pk_add_f32 v[44:45], v[44:45], v[172:173]
    v_pk_add_f32 v[46:47], v[46:47], v[174:175]
    v_cvt_pk_bf16_f32 v168, v40, v41
    v_cvt_pk_bf16_f32 v169, v42, v43
    v_cvt_pk_bf16_f32 v170, v44, v45
    v_cvt_pk_bf16_f32 v171, v46, v47
    s_nop 1
    v_permlane32_swap_b32 v168, v170
    v_permlane32_swap_b32 v169, v171
    buffer_store_dwordx4 v[168:171], v16, s[36:39], s42 offen offset:32
    s_waitcnt vmcnt(4)
    v_pk_add_f32 v[48:49], v[48:49], v[176:177]
    v_pk_add_f32 v[50:51], v[50:51], v[178:179]
    v_pk_add_f32 v[52:53], v[52:53], v[180:181]
    v_pk_add_f32 v[54:55], v[54:55], v[182:183]
    v_cvt_pk_bf16_f32 v176, v48, v49
    v_cvt_pk_bf16_f32 v177, v50, v51
    v_cvt_pk_bf16_f32 v178, v52, v53
    v_cvt_pk_bf16_f32 v179, v54, v55
    s_nop 1
    v_permlane32_swap_b32 v176, v178
    v_permlane32_swap_b32 v177, v179
    buffer_store_dwordx4 v[176:179], v16, s[36:39], s42 offen offset:64
    s_waitcnt vmcnt(3)
    v_pk_add_f32 v[56:57], v[56:57], v[184:185]
    v_pk_add_f32 v[58:59], v[58:59], v[186:187]
    v_pk_add_f32 v[60:61], v[60:61], v[188:189]
    v_pk_add_f32 v[62:63], v[62:63], v[190:191]
    v_cvt_pk_bf16_f32 v184, v56, v57
    v_cvt_pk_bf16_f32 v185, v58, v59
    v_cvt_pk_bf16_f32 v186, v60, v61
    v_cvt_pk_bf16_f32 v187, v62, v63
    s_nop 1
    v_permlane32_swap_b32 v184, v186
    v_permlane32_swap_b32 v185, v187
    buffer_store_dwordx4 v[184:187], v16, s[36:39], s42 offen offset:96
L_END:
    s_endpgm
.section .rodata,"a"
.p2align 6
.amdhsa_kernel standalone__dense_activation_gelu__prompt_kernel
  .amdhsa_next_free_vgpr 240
  .amdhsa_next_free_sgpr 102
  .amdhsa_accum_offset 240
  .amdhsa_group_segment_fixed_size 0
  .amdhsa_kernarg_size 64
  .amdhsa_user_sgpr_count 2
  .amdhsa_user_sgpr_kernarg_segment_ptr 1
  .amdhsa_system_sgpr_workgroup_id_x 1
.end_amdhsa_kernel
```
